```python
import torch

def _softmax(x, axis=-1):
    return torch.softmax(x, dim=axis)
def _gelu(x):
    return torch.nn.functional.gelu(x, approximate="tanh")
def _silu(x):
    return torch.nn.functional.silu(x)
def _sigmoid(x):
    return torch.sigmoid(x)
def _layernorm(x, axis=-1, eps=1e-5):
    m = x.mean(dim=axis, keepdim=True)
    v = x.var(dim=axis, keepdim=True, unbiased=False)
    return (x - m) / torch.sqrt(v + eps)
def _scatter_add(tgt, idx, src, axis=0):
    return tgt.clone().index_add_(axis, idx, src)
def _segment_sum(src, seg, n):
    out = torch.zeros((n,) + src.shape[1:], dtype=src.dtype)
    return out.index_add_(0, seg, src)
def _pad(x, pw):
    flat = tuple(v for pair in reversed(pw) for v in pair)
    return torch.nn.functional.pad(x, flat)

kernel_name = 'sequential_preLN__spectral_gfnet__glu_gated_swiglu__prompt'

def setup_inputs():

    _w = (lambda a: (lambda t: t.to(torch.bfloat16) if t.is_floating_point() else t)(torch.as_tensor(a)))
    def _A_setup():
        B, S, D = 1, 2048, 448
        Df = D // 2 + 1
        return {
            "x": _w((lambda *s: torch.randn(*s, dtype=torch.bfloat16) * 0.05)(B, S, D)),
            "w_r": _w((lambda *s: torch.randn(*s, dtype=torch.bfloat16) * 0.4)(S, Df) * 0.02),
            "w_i": _w((lambda *s: torch.randn(*s, dtype=torch.bfloat16) * 0.4)(S, Df) * 0.02),
        }
    _A_in = _A_setup()

    def _B_setup():
        B, S, D, F = 1, 2048, 448, 1792
        return {
            "x": _w((lambda *s: torch.randn(*s, dtype=torch.bfloat16) * 0.05)(B, S, D)),
            "w1": _w((lambda *s: torch.randn(*s, dtype=torch.bfloat16) * 0.2)(D, F) * (2.0 / D) ** 0.5),
            "w3": _w((lambda *s: torch.randn(*s, dtype=torch.bfloat16) * 0.2)(D, F) * (2.0 / D) ** 0.5),
            "w2": _w((lambda *s: torch.randn(*s, dtype=torch.bfloat16) * 0.2)(F, D) * (2.0 / F) ** 0.5),
        }
    _B_in = _B_setup()

    return {
        "A_x": _A_in["x"],
        "A_w_r": _A_in["w_r"],
        "A_w_i": _A_in["w_i"],
        "B_x": _B_in["x"],
        "B_w1": _B_in["w1"],
        "B_w3": _B_in["w3"],
        "B_w2": _B_in["w2"],
    }

def reference(A_x, A_w_r, A_w_i, B_x, B_w1, B_w3, B_w2):
    def _A_ref(x, w_r, w_i):
        B, S, D = x.shape
        X = (lambda x, axes=(-2,-1): torch.fft.rfft2(x.float(), dim=axes))(x, axes=(-2, -1))
        W = w_r + 1j * w_i
        X = X * W
        y = (lambda x, s, axes=(-2,-1): torch.fft.irfft2(x, s=s, dim=axes).to(torch.bfloat16))(X, (S, D), axes=(-2, -1))
        return y

    def _B_ref(x, w1, w3, w2):
        gate = torch.einsum("bsd,df->bsf", x, w1)
        up = torch.einsum("bsd,df->bsf", x, w3)
        h = _silu(gate) * up
        out = torch.einsum("bsf,fd->bsd", h, w2)
        return out

    x = A_x
    h = x + _A_ref(_layernorm(x, axis=-1), A_w_r, A_w_i)
    h2 = h + _B_ref(_layernorm(h, axis=-1), B_w1, B_w3, B_w2)
    return h2
```

```asm
; @launch kernel=k1_kernel grid=(512,1,1) block=(256,1,1) lds=40960
; @launch kernel=k2_kernel grid=(256,1,1) block=(256,1,1) lds=114688
.amdgcn_target "amdgcn-amd-amdhsa--gfx950"
.text
.globl k1_kernel
.p2align 8
.type k1_kernel,@function
k1_kernel:
  s_cmp_ge_u32 s2, 512
  s_cbranch_scc1 Lk1_end
  s_cmp_ge_u32 s2, 256
  s_cbranch_scc1 Lk1_prep
  s_load_dwordx2 s[40:41], s[0:1], 0
  s_load_dwordx2 s[42:43], s[0:1], 72
  v_mov_b32 v243, v0
  s_lshr_b32 s20, s2, 3
  s_and_b32 s20, s20, 3
  s_and_b32 s24, s2, 7
  s_lshr_b32 s25, s2, 5
  s_lshl_b32 s25, s25, 3
  s_or_b32 s24, s24, s25
  s_and_b32 s21, s24, 31
  s_lshr_b32 s22, s24, 5
  v_lshrrev_b32 v1, 6, v0
  v_and_b32 v0, 63, v0
  v_readfirstlane_b32 s23, v1
  v_and_b32 v2, 31, v0
  v_lshrrev_b32 v3, 5, v0
  v_lshlrev_b32 v4, 4, v0
  s_lshl_b32 s24, s22, 10
  s_add_u32 s24, s24, s21
  s_lshl_b32 s25, s23, 8
  s_add_u32 s24, s24, s25
  s_mul_i32 s24, s24, 896
  s_mul_i32 s25, s23, 7296
  s_waitcnt lgkmcnt(0)
  s_mov_b32 s4, s40
  s_and_b32 s5, s41, 0xffff
  s_mov_b32 s6, 1835008
  s_mov_b32 s7, 0x20000
  s_mov_b32 exec_hi, 0x00ffffff
  s_mov_b32 m0, s25
  s_add_u32 s25, s25, 912
  buffer_load_dwordx4 v4, s[4:7], s24 offen lds
  s_add_u32 s24, s24, 28672
  s_mov_b32 m0, s25
  s_add_u32 s25, s25, 912
  buffer_load_dwordx4 v4, s[4:7], s24 offen lds
  s_add_u32 s24, s24, 28672
  s_mov_b32 m0, s25
  s_add_u32 s25, s25, 912
  buffer_load_dwordx4 v4, s[4:7], s24 offen lds
  s_add_u32 s24, s24, 28672
  s_mov_b32 m0, s25
  s_add_u32 s25, s25, 912
  buffer_load_dwordx4 v4, s[4:7], s24 offen lds
  s_add_u32 s24, s24, 28672
  s_mov_b32 m0, s25
  s_add_u32 s25, s25, 912
  buffer_load_dwordx4 v4, s[4:7], s24 offen lds
  s_add_u32 s24, s24, 28672
  s_mov_b32 m0, s25
  s_add_u32 s25, s25, 912
  buffer_load_dwordx4 v4, s[4:7], s24 offen lds
  s_add_u32 s24, s24, 28672
  s_mov_b32 m0, s25
  s_add_u32 s25, s25, 912
  buffer_load_dwordx4 v4, s[4:7], s24 offen lds
  s_add_u32 s24, s24, 28672
  s_mov_b32 m0, s25
  s_nop 0
  buffer_load_dwordx4 v4, s[4:7], s24 offen lds
  s_mov_b64 exec, -1
  s_getpc_b64 s[12:13]
Lk1_pc:
  s_add_u32 s12, s12, k2_kernel - Lk1_pc
  s_addc_u32 s13, s13, 0
  s_lshr_b32 s14, s2, 3
  s_lshl_b32 s14, s14, 10
  v_lshlrev_b32 v244, 2, v243
  v_add_u32 v244, s14, v244
  v_cmp_gt_u32 vcc, Lk2_codeend - k2_kernel - 4, v244
  s_nop 1
  v_cndmask_b32 v244, 0, v244, vcc
  v_mov_b32 v249, s13
  v_add_co_u32 v248, vcc, s12, v244
  s_nop 1
  v_addc_co_u32 v249, vcc, 0, v249, vcc
  global_load_dword v247, v[248:249], off
  s_mov_b32 s8, s42
  s_and_b32 s9, s43, 0xffff
  s_mov_b32 s10, 33554432
  s_mov_b32 s11, 0x20000
  v_and_b32 v5, 15, v2
  v_lshrrev_b32 v6, 4, v2
  s_lshl_b32 s24, s23, 4
  v_add_u32 v5, s24, v5
  v_mul_u32_u24 v5, 7, v5
  v_add_u32 v5, s20, v5
  v_mov_b32 v7, 0x3e800000
  v_cmp_lt_u32 vcc, 224, v5
  v_mov_b32 v72, 0xbe800000
  s_nop 0
  v_cndmask_b32 v7, v7, v72, vcc
  v_cmp_eq_u32 vcc, 0, v6
  s_nop 1
  v_cndmask_b32 v7, v7, 0, vcc
  v_cvt_f32_u32 v73, v5
  v_mul_f32 v73, 0x3b124925, v73
  v_cvt_f32_u32 v74, v3
  v_mul_f32 v74, 0x41000000, v74
  v_fma_f32 v74, v74, v73, v7
  v_mov_b32 v92, v74
  v_add_f32 v93, v74, v73
  v_add_f32 v102, v73, v73
  v_mul_f32 v103, 0x41800000, v73
  v_cos_f32 v106, v92
  v_cos_f32 v107, v93
  v_sin_f32 v108, v92
  v_sin_f32 v109, v93
  v_cos_f32 v94, v102
  v_sin_f32 v96, v102
  v_cos_f32 v98, v103
  v_sin_f32 v100, v103
  v_pk_mul_f32 v[102:103], v[108:109], v[96:97] op_sel_hi:[1,0]
  v_pk_mul_f32 v[104:105], v[106:107], v[96:97] op_sel_hi:[1,0]
  v_pk_fma_f32 v[110:111], v[106:107], v[94:95], v[102:103] op_sel_hi:[1,0,1] neg_lo:[0,0,1] neg_hi:[0,0,1]
  v_pk_fma_f32 v[112:113], v[108:109], v[94:95], v[104:105] op_sel_hi:[1,0,1]
  v_pk_mul_f32 v[102:103], v[112:113], v[96:97] op_sel_hi:[1,0]
  v_pk_mul_f32 v[104:105], v[110:111], v[96:97] op_sel_hi:[1,0]
  v_pk_fma_f32 v[114:115], v[110:111], v[94:95], v[102:103] op_sel_hi:[1,0,1] neg_lo:[0,0,1] neg_hi:[0,0,1]
  v_pk_fma_f32 v[116:117], v[112:113], v[94:95], v[104:105] op_sel_hi:[1,0,1]
  v_pk_mul_f32 v[102:103], v[116:117], v[96:97] op_sel_hi:[1,0]
  v_pk_mul_f32 v[104:105], v[114:115], v[96:97] op_sel_hi:[1,0]
  v_pk_fma_f32 v[118:119], v[114:115], v[94:95], v[102:103] op_sel_hi:[1,0,1] neg_lo:[0,0,1] neg_hi:[0,0,1]
  v_pk_fma_f32 v[120:121], v[116:117], v[94:95], v[104:105] op_sel_hi:[1,0,1]
  v_cvt_pk_bf16_f32 v40, v106, v107
  v_cvt_pk_bf16_f32 v56, v108, v109
  v_cvt_pk_bf16_f32 v41, v110, v111
  v_cvt_pk_bf16_f32 v57, v112, v113
  v_cvt_pk_bf16_f32 v42, v114, v115
  v_cvt_pk_bf16_f32 v58, v116, v117
  v_cvt_pk_bf16_f32 v43, v118, v119
  v_cvt_pk_bf16_f32 v59, v120, v121
  v_pk_mul_f32 v[102:103], v[108:109], v[100:101] op_sel_hi:[1,0]
  v_pk_mul_f32 v[104:105], v[106:107], v[100:101] op_sel_hi:[1,0]
  v_pk_fma_f32 v[106:107], v[106:107], v[98:99], v[102:103] op_sel_hi:[1,0,1] neg_lo:[0,0,1] neg_hi:[0,0,1]
  v_pk_fma_f32 v[108:109], v[108:109], v[98:99], v[104:105] op_sel_hi:[1,0,1]
  v_pk_mul_f32 v[102:103], v[112:113], v[100:101] op_sel_hi:[1,0]
  v_pk_mul_f32 v[104:105], v[110:111], v[100:101] op_sel_hi:[1,0]
  v_pk_fma_f32 v[110:111], v[110:111], v[98:99], v[102:103] op_sel_hi:[1,0,1] neg_lo:[0,0,1] neg_hi:[0,0,1]
  v_pk_fma_f32 v[112:113], v[112:113], v[98:99], v[104:105] op_sel_hi:[1,0,1]
  v_pk_mul_f32 v[102:103], v[116:117], v[100:101] op_sel_hi:[1,0]
  v_pk_mul_f32 v[104:105], v[114:115], v[100:101] op_sel_hi:[1,0]
  v_pk_fma_f32 v[114:115], v[114:115], v[98:99], v[102:103] op_sel_hi:[1,0,1] neg_lo:[0,0,1] neg_hi:[0,0,1]
  v_pk_fma_f32 v[116:117], v[116:117], v[98:99], v[104:105] op_sel_hi:[1,0,1]
  v_pk_mul_f32 v[102:103], v[120:121], v[100:101] op_sel_hi:[1,0]
  v_pk_mul_f32 v[104:105], v[118:119], v[100:101] op_sel_hi:[1,0]
  v_pk_fma_f32 v[118:119], v[118:119], v[98:99], v[102:103] op_sel_hi:[1,0,1] neg_lo:[0,0,1] neg_hi:[0,0,1]
  v_pk_fma_f32 v[120:121], v[120:121], v[98:99], v[104:105] op_sel_hi:[1,0,1]
  v_cvt_pk_bf16_f32 v44, v106, v107
  v_cvt_pk_bf16_f32 v60, v108, v109
  v_cvt_pk_bf16_f32 v45, v110, v111
  v_cvt_pk_bf16_f32 v61, v112, v113
  v_cvt_pk_bf16_f32 v46, v114, v115
  v_cvt_pk_bf16_f32 v62, v116, v117
  v_cvt_pk_bf16_f32 v47, v118, v119
  v_cvt_pk_bf16_f32 v63, v120, v121
  v_pk_mul_f32 v[102:103], v[108:109], v[100:101] op_sel_hi:[1,0]
  v_pk_mul_f32 v[104:105], v[106:107], v[100:101] op_sel_hi:[1,0]
  v_pk_fma_f32 v[106:107], v[106:107], v[98:99], v[102:103] op_sel_hi:[1,0,1] neg_lo:[0,0,1] neg_hi:[0,0,1]
  v_pk_fma_f32 v[108:109], v[108:109], v[98:99], v[104:105] op_sel_hi:[1,0,1]
  v_pk_mul_f32 v[102:103], v[112:113], v[100:101] op_sel_hi:[1,0]
  v_pk_mul_f32 v[104:105], v[110:111], v[100:101] op_sel_hi:[1,0]
  v_pk_fma_f32 v[110:111], v[110:111], v[98:99], v[102:103] op_sel_hi:[1,0,1] neg_lo:[0,0,1] neg_hi:[0,0,1]
  v_pk_fma_f32 v[112:113], v[112:113], v[98:99], v[104:105] op_sel_hi:[1,0,1]
  v_pk_mul_f32 v[102:103], v[116:117], v[100:101] op_sel_hi:[1,0]
  v_pk_mul_f32 v[104:105], v[114:115], v[100:101] op_sel_hi:[1,0]
  v_pk_fma_f32 v[114:115], v[114:115], v[98:99], v[102:103] op_sel_hi:[1,0,1] neg_lo:[0,0,1] neg_hi:[0,0,1]
  v_pk_fma_f32 v[116:117], v[116:117], v[98:99], v[104:105] op_sel_hi:[1,0,1]
  v_pk_mul_f32 v[102:103], v[120:121], v[100:101] op_sel_hi:[1,0]
  v_pk_mul_f32 v[104:105], v[118:119], v[100:101] op_sel_hi:[1,0]
  v_pk_fma_f32 v[118:119], v[118:119], v[98:99], v[102:103] op_sel_hi:[1,0,1] neg_lo:[0,0,1] neg_hi:[0,0,1]
  v_pk_fma_f32 v[120:121], v[120:121], v[98:99], v[104:105] op_sel_hi:[1,0,1]
  v_cvt_pk_bf16_f32 v48, v106, v107
  v_cvt_pk_bf16_f32 v64, v108, v109
  v_cvt_pk_bf16_f32 v49, v110, v111
  v_cvt_pk_bf16_f32 v65, v112, v113
  v_cvt_pk_bf16_f32 v50, v114, v115
  v_cvt_pk_bf16_f32 v66, v116, v117
  v_cvt_pk_bf16_f32 v51, v118, v119
  v_cvt_pk_bf16_f32 v67, v120, v121
  v_pk_mul_f32 v[102:103], v[108:109], v[100:101] op_sel_hi:[1,0]
  v_pk_mul_f32 v[104:105], v[106:107], v[100:101] op_sel_hi:[1,0]
  v_pk_fma_f32 v[106:107], v[106:107], v[98:99], v[102:103] op_sel_hi:[1,0,1] neg_lo:[0,0,1] neg_hi:[0,0,1]
  v_pk_fma_f32 v[108:109], v[108:109], v[98:99], v[104:105] op_sel_hi:[1,0,1]
  v_pk_mul_f32 v[102:103], v[112:113], v[100:101] op_sel_hi:[1,0]
  v_pk_mul_f32 v[104:105], v[110:111], v[100:101] op_sel_hi:[1,0]
  v_pk_fma_f32 v[110:111], v[110:111], v[98:99], v[102:103] op_sel_hi:[1,0,1] neg_lo:[0,0,1] neg_hi:[0,0,1]
  v_pk_fma_f32 v[112:113], v[112:113], v[98:99], v[104:105] op_sel_hi:[1,0,1]
  v_pk_mul_f32 v[102:103], v[116:117], v[100:101] op_sel_hi:[1,0]
  v_pk_mul_f32 v[104:105], v[114:115], v[100:101] op_sel_hi:[1,0]
  v_pk_fma_f32 v[114:115], v[114:115], v[98:99], v[102:103] op_sel_hi:[1,0,1] neg_lo:[0,0,1] neg_hi:[0,0,1]
  v_pk_fma_f32 v[116:117], v[116:117], v[98:99], v[104:105] op_sel_hi:[1,0,1]
  v_pk_mul_f32 v[102:103], v[120:121], v[100:101] op_sel_hi:[1,0]
  v_pk_mul_f32 v[104:105], v[118:119], v[100:101] op_sel_hi:[1,0]
  v_pk_fma_f32 v[118:119], v[118:119], v[98:99], v[102:103] op_sel_hi:[1,0,1] neg_lo:[0,0,1] neg_hi:[0,0,1]
  v_pk_fma_f32 v[120:121], v[120:121], v[98:99], v[104:105] op_sel_hi:[1,0,1]
  v_cvt_pk_bf16_f32 v52, v106, v107
  v_cvt_pk_bf16_f32 v68, v108, v109
  v_cvt_pk_bf16_f32 v53, v110, v111
  v_cvt_pk_bf16_f32 v69, v112, v113
  v_cvt_pk_bf16_f32 v54, v114, v115
  v_cvt_pk_bf16_f32 v70, v116, v117
  v_cvt_pk_bf16_f32 v55, v118, v119
  v_cvt_pk_bf16_f32 v71, v120, v121
  v_sub_u32 v76, 448, v5
  v_cmp_lt_u32 vcc, 224, v5
  s_nop 1
  v_cndmask_b32 v76, v5, v76, vcc
  v_subrev_u32 v77, 1, v76
  v_mul_u32_u24 v77, 8448, v77
  s_lshl_b32 s24, s21, 8
  v_add_u32 v77, s24, v77
  v_lshl_add_u32 v78, v6, 2, v3
  s_lshl_b32 s25, s22, 3
  s_and_b32 s26, s21, 15
  s_xor_b32 s25, s25, s26
  v_xor_b32 v78, s25, v78
  v_xor_b32 v79, 2, v78
  v_lshl_add_u32 v74, v78, 4, v77
  v_lshl_add_u32 v75, v79, 4, v77
  v_subrev_u32 v78, 1, v5
  v_cmp_le_u32 vcc, 224, v78
  s_cmp_eq_u32 s20, 0
  s_nop 2
  s_cselect_b64 s[26:27], vcc, 0
  v_mov_b32 v79, 2146435072
  v_cndmask_b32 v6, v74, v79, s[26:27]
  v_cndmask_b32 v7, v75, v79, s[26:27]
  v_cvt_f32_u32 v76, s20
  v_mul_f32 v77, 0x3e124925, v76
  v_cos_f32 v80, v77
  v_sin_f32 v86, -v77
  v_mul_f32 v77, 0x3e924925, v76
  v_cos_f32 v82, v77
  v_sin_f32 v88, -v77
  v_mul_f32 v77, 0x3edb6db7, v76
  v_cos_f32 v84, v77
  v_sin_f32 v90, -v77
  s_cmp_eq_u32 s20, 0
  s_cselect_b32 s28, 0xc0e00000, 0
  v_mul_u32_u24 v76, 912, v2
  v_lshl_add_u32 v77, v3, 4, v76
  s_lshl_b32 s24, s23, 5
  v_add_u32 v77, s24, v77
  s_waitcnt vmcnt(1)
  s_barrier
  ds_read_b128 v[8:11], v77 offset:0
  ds_read_b128 v[12:15], v77 offset:128
  ds_read_b128 v[16:19], v77 offset:256
  ds_read_b128 v[20:23], v77 offset:384
  ds_read_b128 v[24:27], v77 offset:512
  ds_read_b128 v[28:31], v77 offset:640
  ds_read_b128 v[32:35], v77 offset:768
  ds_read_u16 v78, v76
  s_waitcnt lgkmcnt(7)
  v_lshlrev_b32 v92, 16, v8
  v_and_b32 v93, 0xffff0000, v8
  s_waitcnt lgkmcnt(6)
  v_lshlrev_b32 v94, 16, v12
  v_and_b32 v95, 0xffff0000, v12
  s_waitcnt lgkmcnt(5)
  v_lshlrev_b32 v96, 16, v16
  v_and_b32 v97, 0xffff0000, v16
  s_waitcnt lgkmcnt(4)
  v_lshlrev_b32 v98, 16, v20
  v_and_b32 v99, 0xffff0000, v20
  s_waitcnt lgkmcnt(3)
  v_lshlrev_b32 v100, 16, v24
  v_and_b32 v101, 0xffff0000, v24
  s_waitcnt lgkmcnt(2)
  v_lshlrev_b32 v102, 16, v28
  v_and_b32 v103, 0xffff0000, v28
  s_waitcnt lgkmcnt(1)
  v_lshlrev_b32 v104, 16, v32
  v_and_b32 v105, 0xffff0000, v32
  s_waitcnt lgkmcnt(0)
  v_lshlrev_b32 v78, 16, v78
  v_mul_f32 v142, s28, v78
  v_pk_add_f32 v[106:107], v[94:95], v[104:105]
  v_pk_add_f32 v[112:113], v[94:95], v[104:105] neg_lo:[0,1] neg_hi:[0,1]
  v_pk_add_f32 v[108:109], v[96:97], v[102:103]
  v_pk_add_f32 v[114:115], v[96:97], v[102:103] neg_lo:[0,1] neg_hi:[0,1]
  v_pk_add_f32 v[110:111], v[98:99], v[100:101]
  v_pk_add_f32 v[116:117], v[98:99], v[100:101] neg_lo:[0,1] neg_hi:[0,1]
  v_pk_fma_f32 v[120:121], v[106:107], v[80:81], v[92:93] op_sel_hi:[1,0,1]
  v_pk_mul_f32 v[128:129], v[112:113], v[86:87] op_sel_hi:[1,0]
  v_pk_fma_f32 v[120:121], v[108:109], v[82:83], v[120:121] op_sel_hi:[1,0,1]
  v_pk_fma_f32 v[128:129], v[114:115], v[88:89], v[128:129] op_sel_hi:[1,0,1]
  v_pk_fma_f32 v[120:121], v[110:111], v[84:85], v[120:121] op_sel_hi:[1,0,1]
  v_pk_fma_f32 v[128:129], v[116:117], v[90:91], v[128:129] op_sel_hi:[1,0,1]
  v_pk_add_f32 v[120:121], v[120:121], v[142:143] op_sel_hi:[1,0]
  v_cvt_pk_bf16_f32 v152, v120, v121
  v_cvt_pk_bf16_f32 v156, v128, v129
  v_pk_add_f32 v[140:141], v[106:107], v[108:109]
  v_pk_add_f32 v[136:137], v[110:111], v[92:93]
  v_pk_add_f32 v[136:137], v[136:137], v[140:141]
  v_pk_mul_f32 v[138:139], v[92:93], v[92:93]
  v_pk_fma_f32 v[138:139], v[94:95], v[94:95], v[138:139]
  v_pk_fma_f32 v[138:139], v[96:97], v[96:97], v[138:139]
  v_pk_fma_f32 v[138:139], v[98:99], v[98:99], v[138:139]
  v_pk_fma_f32 v[138:139], v[100:101], v[100:101], v[138:139]
  v_pk_fma_f32 v[138:139], v[102:103], v[102:103], v[138:139]
  v_pk_fma_f32 v[138:139], v[104:105], v[104:105], v[138:139]
  v_lshlrev_b32 v92, 16, v9
  v_and_b32 v93, 0xffff0000, v9
  v_lshlrev_b32 v94, 16, v13
  v_and_b32 v95, 0xffff0000, v13
  v_lshlrev_b32 v96, 16, v17
  v_and_b32 v97, 0xffff0000, v17
  v_lshlrev_b32 v98, 16, v21
  v_and_b32 v99, 0xffff0000, v21
  v_lshlrev_b32 v100, 16, v25
  v_and_b32 v101, 0xffff0000, v25
  v_lshlrev_b32 v102, 16, v29
  v_and_b32 v103, 0xffff0000, v29
  v_lshlrev_b32 v104, 16, v33
  v_and_b32 v105, 0xffff0000, v33
  v_pk_add_f32 v[106:107], v[94:95], v[104:105]
  v_pk_add_f32 v[112:113], v[94:95], v[104:105] neg_lo:[0,1] neg_hi:[0,1]
  v_pk_add_f32 v[108:109], v[96:97], v[102:103]
  v_pk_add_f32 v[114:115], v[96:97], v[102:103] neg_lo:[0,1] neg_hi:[0,1]
  v_pk_add_f32 v[110:111], v[98:99], v[100:101]
  v_pk_add_f32 v[116:117], v[98:99], v[100:101] neg_lo:[0,1] neg_hi:[0,1]
  v_pk_fma_f32 v[122:123], v[106:107], v[80:81], v[92:93] op_sel_hi:[1,0,1]
  v_pk_mul_f32 v[130:131], v[112:113], v[86:87] op_sel_hi:[1,0]
  v_pk_fma_f32 v[122:123], v[108:109], v[82:83], v[122:123] op_sel_hi:[1,0,1]
  v_pk_fma_f32 v[130:131], v[114:115], v[88:89], v[130:131] op_sel_hi:[1,0,1]
  v_pk_fma_f32 v[122:123], v[110:111], v[84:85], v[122:123] op_sel_hi:[1,0,1]
  v_pk_fma_f32 v[130:131], v[116:117], v[90:91], v[130:131] op_sel_hi:[1,0,1]
  v_pk_add_f32 v[122:123], v[122:123], v[142:143] op_sel_hi:[1,0]
  v_cvt_pk_bf16_f32 v153, v122, v123
  v_cvt_pk_bf16_f32 v157, v130, v131
  v_pk_add_f32 v[140:141], v[106:107], v[108:109]
  v_pk_add_f32 v[136:137], v[136:137], v[110:111]
  v_pk_add_f32 v[136:137], v[136:137], v[92:93]
  v_pk_add_f32 v[136:137], v[136:137], v[140:141]
  v_pk_fma_f32 v[138:139], v[92:93], v[92:93], v[138:139]
  v_pk_fma_f32 v[138:139], v[94:95], v[94:95], v[138:139]
  v_pk_fma_f32 v[138:139], v[96:97], v[96:97], v[138:139]
  v_pk_fma_f32 v[138:139], v[98:99], v[98:99], v[138:139]
  v_pk_fma_f32 v[138:139], v[100:101], v[100:101], v[138:139]
  v_pk_fma_f32 v[138:139], v[102:103], v[102:103], v[138:139]
  v_pk_fma_f32 v[138:139], v[104:105], v[104:105], v[138:139]
  v_lshlrev_b32 v92, 16, v10
  v_and_b32 v93, 0xffff0000, v10
  v_lshlrev_b32 v94, 16, v14
  v_and_b32 v95, 0xffff0000, v14
  v_lshlrev_b32 v96, 16, v18
  v_and_b32 v97, 0xffff0000, v18
  v_lshlrev_b32 v98, 16, v22
  v_and_b32 v99, 0xffff0000, v22
  v_lshlrev_b32 v100, 16, v26
  v_and_b32 v101, 0xffff0000, v26
  v_lshlrev_b32 v102, 16, v30
  v_and_b32 v103, 0xffff0000, v30
  v_lshlrev_b32 v104, 16, v34
  v_and_b32 v105, 0xffff0000, v34
  v_pk_add_f32 v[106:107], v[94:95], v[104:105]
  v_pk_add_f32 v[112:113], v[94:95], v[104:105] neg_lo:[0,1] neg_hi:[0,1]
  v_pk_add_f32 v[108:109], v[96:97], v[102:103]
  v_pk_add_f32 v[114:115], v[96:97], v[102:103] neg_lo:[0,1] neg_hi:[0,1]
  v_pk_add_f32 v[110:111], v[98:99], v[100:101]
  v_pk_add_f32 v[116:117], v[98:99], v[100:101] neg_lo:[0,1] neg_hi:[0,1]
  v_pk_fma_f32 v[124:125], v[106:107], v[80:81], v[92:93] op_sel_hi:[1,0,1]
  v_pk_mul_f32 v[132:133], v[112:113], v[86:87] op_sel_hi:[1,0]
  v_pk_fma_f32 v[124:125], v[108:109], v[82:83], v[124:125] op_sel_hi:[1,0,1]
  v_pk_fma_f32 v[132:133], v[114:115], v[88:89], v[132:133] op_sel_hi:[1,0,1]
  v_pk_fma_f32 v[124:125], v[110:111], v[84:85], v[124:125] op_sel_hi:[1,0,1]
  v_pk_fma_f32 v[132:133], v[116:117], v[90:91], v[132:133] op_sel_hi:[1,0,1]
  v_pk_add_f32 v[124:125], v[124:125], v[142:143] op_sel_hi:[1,0]
  v_cvt_pk_bf16_f32 v154, v124, v125
  v_cvt_pk_bf16_f32 v158, v132, v133
  v_pk_add_f32 v[140:141], v[106:107], v[108:109]
  v_pk_add_f32 v[136:137], v[136:137], v[110:111]
  v_pk_add_f32 v[136:137], v[136:137], v[92:93]
  v_pk_add_f32 v[136:137], v[136:137], v[140:141]
  v_pk_fma_f32 v[138:139], v[92:93], v[92:93], v[138:139]
  v_pk_fma_f32 v[138:139], v[94:95], v[94:95], v[138:139]
  v_pk_fma_f32 v[138:139], v[96:97], v[96:97], v[138:139]
  v_pk_fma_f32 v[138:139], v[98:99], v[98:99], v[138:139]
  v_pk_fma_f32 v[138:139], v[100:101], v[100:101], v[138:139]
  v_pk_fma_f32 v[138:139], v[102:103], v[102:103], v[138:139]
  v_pk_fma_f32 v[138:139], v[104:105], v[104:105], v[138:139]
  v_lshlrev_b32 v92, 16, v11
  v_and_b32 v93, 0xffff0000, v11
  v_lshlrev_b32 v94, 16, v15
  v_and_b32 v95, 0xffff0000, v15
  v_lshlrev_b32 v96, 16, v19
  v_and_b32 v97, 0xffff0000, v19
  v_lshlrev_b32 v98, 16, v23
  v_and_b32 v99, 0xffff0000, v23
  v_lshlrev_b32 v100, 16, v27
  v_and_b32 v101, 0xffff0000, v27
  v_lshlrev_b32 v102, 16, v31
  v_and_b32 v103, 0xffff0000, v31
  v_lshlrev_b32 v104, 16, v35
  v_and_b32 v105, 0xffff0000, v35
  v_pk_add_f32 v[106:107], v[94:95], v[104:105]
  v_pk_add_f32 v[112:113], v[94:95], v[104:105] neg_lo:[0,1] neg_hi:[0,1]
  v_pk_add_f32 v[108:109], v[96:97], v[102:103]
  v_pk_add_f32 v[114:115], v[96:97], v[102:103] neg_lo:[0,1] neg_hi:[0,1]
  v_pk_add_f32 v[110:111], v[98:99], v[100:101]
  v_pk_add_f32 v[116:117], v[98:99], v[100:101] neg_lo:[0,1] neg_hi:[0,1]
  v_pk_fma_f32 v[126:127], v[106:107], v[80:81], v[92:93] op_sel_hi:[1,0,1]
  v_pk_mul_f32 v[134:135], v[112:113], v[86:87] op_sel_hi:[1,0]
  v_pk_fma_f32 v[126:127], v[108:109], v[82:83], v[126:127] op_sel_hi:[1,0,1]
  v_pk_fma_f32 v[134:135], v[114:115], v[88:89], v[134:135] op_sel_hi:[1,0,1]
  v_pk_fma_f32 v[126:127], v[110:111], v[84:85], v[126:127] op_sel_hi:[1,0,1]
  v_pk_fma_f32 v[134:135], v[116:117], v[90:91], v[134:135] op_sel_hi:[1,0,1]
  v_pk_add_f32 v[126:127], v[126:127], v[142:143] op_sel_hi:[1,0]
  v_cvt_pk_bf16_f32 v155, v126, v127
  v_cvt_pk_bf16_f32 v159, v134, v135
  v_pk_add_f32 v[140:141], v[106:107], v[108:109]
  v_pk_add_f32 v[136:137], v[136:137], v[110:111]
  v_pk_add_f32 v[136:137], v[136:137], v[92:93]
  v_pk_add_f32 v[136:137], v[136:137], v[140:141]
  v_pk_fma_f32 v[138:139], v[92:93], v[92:93], v[138:139]
  v_pk_fma_f32 v[138:139], v[94:95], v[94:95], v[138:139]
  v_pk_fma_f32 v[138:139], v[96:97], v[96:97], v[138:139]
  v_pk_fma_f32 v[138:139], v[98:99], v[98:99], v[138:139]
  v_pk_fma_f32 v[138:139], v[100:101], v[100:101], v[138:139]
  v_pk_fma_f32 v[138:139], v[102:103], v[102:103], v[138:139]
  v_pk_fma_f32 v[138:139], v[104:105], v[104:105], v[138:139]
  v_mul_u32_u24 v76, 272, v2
  v_lshl_add_u32 v77, v3, 4, v76
  s_lshl_b32 s24, s23, 5
  v_add_u32 v78, s24, v77
  ds_write_b128 v78, v[152:155] offset:29184
  ds_write_b128 v78, v[156:159] offset:29312
  v_add_f32 v136, v136, v137
  v_add_f32 v137, v138, v139
  v_mov_b32 v138, v136
  v_mov_b32 v139, v137
  s_nop 0
  v_permlane32_swap_b32 v136, v138
  v_permlane32_swap_b32 v137, v139
  v_pk_add_f32 v[136:137], v[136:137], v[138:139]
  v_lshlrev_b32 v76, 3, v2
  s_lshl_b32 s24, s23, 8
  v_add_u32 v79, s24, v76
  ds_write_b64 v79, v[136:137] offset:37888
  s_waitcnt lgkmcnt(0)
  s_barrier
  ds_read_b64 v[142:143], v76 offset:37888
  ds_read_b64 v[144:145], v76 offset:38144
  ds_read_b64 v[146:147], v76 offset:38400
  ds_read_b64 v[148:149], v76 offset:38656
  ds_read_b128 v[160:163], v77 offset:29184
  ds_read_b128 v[176:179], v77 offset:29312
  ds_read_b128 v[164:167], v77 offset:29216
  ds_read_b128 v[180:183], v77 offset:29344
  ds_read_b128 v[168:171], v77 offset:29248
  ds_read_b128 v[184:187], v77 offset:29376
  ds_read_b128 v[172:175], v77 offset:29280
  ds_read_b128 v[188:191], v77 offset:29408
  s_waitcnt lgkmcnt(7)
  v_mfma_f32_32x32x16_bf16 v[192:207], v[160:163], v[40:43], 0
  v_pk_add_f32 v[142:143], v[142:143], v[144:145]
  v_pk_add_f32 v[146:147], v[146:147], v[148:149]
  v_pk_add_f32 v[142:143], v[142:143], v[146:147]
  s_waitcnt lgkmcnt(6)
  v_mfma_f32_32x32x16_bf16 v[192:207], v[176:179], v[56:59], v[192:207]
  v_mul_f32 v142, 0x3b124925, v142
  v_mul_f32 v143, 0x3b124925, v143
  v_fma_f32 v143, -v142, v142, v143
  s_waitcnt lgkmcnt(5)
  v_mfma_f32_32x32x16_bf16 v[192:207], v[164:167], v[44:47], v[192:207]
  v_max_f32 v143, 0, v143
  v_add_f32 v143, 0x3727c5ac, v143
  v_rsq_f32 v144, v143
  s_waitcnt lgkmcnt(4)
  v_mfma_f32_32x32x16_bf16 v[192:207], v[180:183], v[60:63], v[192:207]
  v_lshlrev_b32 v145, 2, v2
  s_lshl_b32 s24, s23, 7
  v_add_u32 v145, s24, v145
  s_waitcnt lgkmcnt(3)
  v_mfma_f32_32x32x16_bf16 v[192:207], v[168:171], v[48:51], v[192:207]
  ds_write_b32 v145, v144 offset:38912
  v_lshlrev_b32 v146, 4, v3
  v_add_u32 v146, s24, v146
  s_waitcnt lgkmcnt(3)
  v_mfma_f32_32x32x16_bf16 v[192:207], v[184:187], v[64:67], v[192:207]
  s_waitcnt lgkmcnt(0)
  ds_read_b128 v[8:11], v146 offset:38912
  ds_read_b128 v[12:15], v146 offset:38944
  v_mfma_f32_32x32x16_bf16 v[192:207], v[172:175], v[52:55], v[192:207]
  ds_read_b128 v[16:19], v146 offset:38976
  ds_read_b128 v[20:23], v146 offset:39008
  v_mfma_f32_32x32x16_bf16 v[192:207], v[188:191], v[68:71], v[192:207]
  s_waitcnt lgkmcnt(3)
  s_nop 10
  v_pk_mul_f32 v[192:193], v[192:193], v[8:9]
  v_pk_mul_f32 v[194:195], v[194:195], v[10:11]
  v_cvt_pk_bf16_f32 v208, v192, v193
  v_cvt_pk_bf16_f32 v209, v194, v195
  s_waitcnt lgkmcnt(2)
  v_pk_mul_f32 v[196:197], v[196:197], v[12:13]
  v_pk_mul_f32 v[198:199], v[198:199], v[14:15]
  v_cvt_pk_bf16_f32 v210, v196, v197
  v_cvt_pk_bf16_f32 v211, v198, v199
  s_waitcnt lgkmcnt(1)
  v_pk_mul_f32 v[200:201], v[200:201], v[16:17]
  v_pk_mul_f32 v[202:203], v[202:203], v[18:19]
  v_cvt_pk_bf16_f32 v212, v200, v201
  v_cvt_pk_bf16_f32 v213, v202, v203
  s_waitcnt lgkmcnt(0)
  v_pk_mul_f32 v[204:205], v[204:205], v[20:21]
  v_pk_mul_f32 v[206:207], v[206:207], v[22:23]
  v_cvt_pk_bf16_f32 v214, v204, v205
  v_cvt_pk_bf16_f32 v215, v206, v207
  v_permlane32_swap_b32 v208, v210
  v_permlane32_swap_b32 v209, v211
  v_permlane32_swap_b32 v212, v214
  v_permlane32_swap_b32 v213, v215
  s_mov_b32 s29, 0
  v_mov_b32_dpp v216, v212 row_ror:8 row_mask:0xf bank_mask:0xf
  v_mov_b32_dpp v217, v213 row_ror:8 row_mask:0xf bank_mask:0xf
  v_mov_b32_dpp v218, v214 row_ror:8 row_mask:0xf bank_mask:0xf
  v_mov_b32_dpp v219, v215 row_ror:8 row_mask:0xf bank_mask:0xf
  v_mov_b32_dpp v220, v7 row_ror:8 row_mask:0xf bank_mask:0xf
  v_and_b32 v221, 8, v0
  v_cmp_eq_u32 vcc, 0, v221
  s_nop 1
  v_cndmask_b32 v224, v216, v208, vcc
  v_cndmask_b32 v228, v208, v216, vcc
  v_cndmask_b32 v225, v217, v209, vcc
  v_cndmask_b32 v229, v209, v217, vcc
  v_cndmask_b32 v226, v218, v210, vcc
  v_cndmask_b32 v230, v210, v218, vcc
  v_cndmask_b32 v227, v219, v211, vcc
  v_cndmask_b32 v231, v211, v219, vcc
  v_cndmask_b32 v222, v220, v6, vcc
  v_cndmask_b32 v223, v6, v220, vcc
  buffer_store_dwordx4 v[224:227], v222, s[8:11], s29 offen sc1
  buffer_store_dwordx4 v[228:231], v223, s[8:11], s29 offen sc1
  s_endpgm
Lk1_prep:
  s_load_dwordx2 s[42:43], s[0:1], 72
  s_load_dwordx4 s[44:47], s[0:1], 8
  s_load_dwordx4 s[48:51], s[0:1], 32
  s_load_dwordx2 s[52:53], s[0:1], 48
  s_sub_u32 s30, s2, 256
  v_lshrrev_b32 v1, 6, v0
  v_and_b32 v2, 63, v0
  v_readfirstlane_b32 s31, v1
  s_nop 3
  s_cmp_eq_u32 s31, 2
  s_movk_i32 s32, 4682
  s_cselect_b32 s32, 2341, s32
  s_cselect_b32 s33, 28, 14
  s_movk_i32 s34, 3584
  s_cselect_b32 s34, 896, s34
  v_add_u32 v20, 0, v2
  v_mul_u32_u24 v21, s32, v20
  v_lshrrev_b32 v21, 16, v21
  v_mul_u32_u24 v22, s33, v21
  v_sub_u32 v22, v20, v22
  v_mul_u32_u24 v21, s34, v21
  v_lshl_add_u32 v40, v22, 4, v21
  v_add_u32 v20, 64, v2
  v_mul_u32_u24 v21, s32, v20
  v_lshrrev_b32 v21, 16, v21
  v_mul_u32_u24 v22, s33, v21
  v_sub_u32 v22, v20, v22
  v_mul_u32_u24 v21, s34, v21
  v_lshl_add_u32 v41, v22, 4, v21
  v_add_u32 v20, 128, v2
  v_mul_u32_u24 v21, s32, v20
  v_lshrrev_b32 v21, 16, v21
  v_mul_u32_u24 v22, s33, v21
  v_sub_u32 v22, v20, v22
  v_mul_u32_u24 v21, s34, v21
  v_lshl_add_u32 v42, v22, 4, v21
  v_add_u32 v20, 192, v2
  v_mul_u32_u24 v21, s32, v20
  v_lshrrev_b32 v21, 16, v21
  v_mul_u32_u24 v22, s33, v21
  v_sub_u32 v22, v20, v22
  v_mul_u32_u24 v21, s34, v21
  v_lshl_add_u32 v43, v22, 4, v21
  v_add_u32 v20, 256, v2
  v_mul_u32_u24 v21, s32, v20
  v_lshrrev_b32 v21, 16, v21
  v_mul_u32_u24 v22, s33, v21
  v_sub_u32 v22, v20, v22
  v_mul_u32_u24 v21, s34, v21
  v_lshl_add_u32 v44, v22, 4, v21
  v_add_u32 v20, 320, v2
  v_mul_u32_u24 v21, s32, v20
  v_lshrrev_b32 v21, 16, v21
  v_mul_u32_u24 v22, s33, v21
  v_sub_u32 v22, v20, v22
  v_mul_u32_u24 v21, s34, v21
  v_lshl_add_u32 v45, v22, 4, v21
  v_add_u32 v20, 384, v2
  v_mul_u32_u24 v21, s32, v20
  v_lshrrev_b32 v21, 16, v21
  v_mul_u32_u24 v22, s33, v21
  v_sub_u32 v22, v20, v22
  v_mul_u32_u24 v21, s34, v21
  v_lshl_add_u32 v46, v22, 4, v21
  s_and_b32 s92, s30, 7
  s_lshr_b32 s93, s30, 3
  s_lshr_b32 s38, s93, 4
  s_lshl_b32 s38, s38, 3
  s_add_u32 s38, s38, s92
  s_and_b32 s39, s93, 15
  s_mul_i32 s60, s38, 114688
  s_mul_i32 s61, s39, 224
  s_add_u32 s60, s60, s61
  s_lshr_b32 s40, s93, 1
  s_lshl_b32 s40, s40, 3
  s_add_u32 s40, s40, s92
  s_and_b32 s41, s93, 1
  s_mul_i32 s62, s40, 14336
  s_mul_i32 s63, s41, 448
  s_add_u32 s62, s62, s63
  s_cmp_eq_u32 s31, 2
  s_cselect_b32 s60, s62, s60
  s_mul_i32 s64, s31, 7296
  s_cselect_b32 s64, 16384, s64
  s_lshr_b32 s35, s93, 2
  s_lshl_b32 s35, s35, 3
  s_add_u32 s35, s35, s92
  s_and_b32 s36, s93, 3
  s_mov_b32 s97, s35
  s_mul_i32 s96, s36, 56
  s_lshl_b32 s35, s35, 5
  s_lshl_b32 s37, s31, 3
  s_add_u32 s35, s35, s37
  s_mul_i32 s36, s36, 56
  v_add_u32 v3, s36, v2
  v_cmp_gt_u32 vcc, 56, v2
  v_mov_b32 v5, 2146435072
  v_lshlrev_b32 v4, 1, v3
  v_add_u32 v4, 2, v4
  v_cndmask_b32 v4, v5, v4, vcc
  v_mul_u32_u24 v6, 8448, v3
  s_lshl_b32 s37, s35, 2
  v_add_u32 v6, s37, v6
  v_cndmask_b32 v6, v5, v6, vcc
  s_mul_i32 s36, s35, 450
  s_waitcnt lgkmcnt(0)
  s_mov_b32 s8, s42
  s_and_b32 s9, s43, 0xffff
  s_mov_b32 s10, 33554432
  s_mov_b32 s11, 0x20000
  s_cmp_eq_u32 s31, 1
  s_cselect_b32 s16, s50, s48
  s_cselect_b32 s17, s51, s49
  s_cmp_eq_u32 s31, 2
  s_cselect_b32 s16, s52, s16
  s_cselect_b32 s17, s53, s17
  s_and_b32 s17, s17, 0xffff
  s_mov_b32 s18, 1605632
  s_mov_b32 s19, 0x20000
  s_cmp_lt_u32 s38, 14
  s_cselect_b32 s94, 1, 0
  s_cmp_lt_u32 s30, 224
  s_cselect_b32 s95, 1, 0
  s_cmp_eq_u32 s31, 2
  s_cselect_b32 s54, s95, s94
  s_cmp_eq_u32 s54, 0
  s_cbranch_scc1 Lprep_nodma
  s_cmp_eq_u32 s31, 3
  s_cbranch_scc1 Lprep_nodma
  s_mov_b32 m0, s64
  s_add_u32 s64, s64, 1024
  buffer_load_dwordx4 v40, s[16:19], s60 offen lds
  s_mov_b32 m0, s64
  s_add_u32 s64, s64, 1024
  buffer_load_dwordx4 v41, s[16:19], s60 offen lds
  s_mov_b32 m0, s64
  s_add_u32 s64, s64, 1024
  buffer_load_dwordx4 v42, s[16:19], s60 offen lds
  s_mov_b32 m0, s64
  s_add_u32 s64, s64, 1024
  buffer_load_dwordx4 v43, s[16:19], s60 offen lds
  s_mov_b32 m0, s64
  s_add_u32 s64, s64, 1024
  buffer_load_dwordx4 v44, s[16:19], s60 offen lds
  s_mov_b32 m0, s64
  s_add_u32 s64, s64, 1024
  buffer_load_dwordx4 v45, s[16:19], s60 offen lds
  s_mov_b32 m0, s64
  s_add_u32 s64, s64, 1024
  buffer_load_dwordx4 v46, s[16:19], s60 offen lds
Lprep_nodma:
  s_mov_b32 s4, s44
  s_and_b32 s5, s45, 0xffff
  s_mov_b32 s6, 921600
  s_mov_b32 s7, 0x20000
  s_mov_b32 s12, s46
  s_and_b32 s13, s47, 0xffff
  s_mov_b32 s14, 921600
  s_mov_b32 s15, 0x20000
  buffer_load_ushort v8, v4, s[4:7], s36 offen offset:0
  buffer_load_ushort v24, v4, s[12:15], s36 offen offset:0
  buffer_load_ushort v9, v4, s[4:7], s36 offen offset:450
  buffer_load_ushort v25, v4, s[12:15], s36 offen offset:450
  buffer_load_ushort v10, v4, s[4:7], s36 offen offset:900
  buffer_load_ushort v26, v4, s[12:15], s36 offen offset:900
  buffer_load_ushort v11, v4, s[4:7], s36 offen offset:1350
  buffer_load_ushort v27, v4, s[12:15], s36 offen offset:1350
  buffer_load_ushort v12, v4, s[4:7], s36 offen offset:1800
  buffer_load_ushort v28, v4, s[12:15], s36 offen offset:1800
  buffer_load_ushort v13, v4, s[4:7], s36 offen offset:2250
  buffer_load_ushort v29, v4, s[12:15], s36 offen offset:2250
  buffer_load_ushort v14, v4, s[4:7], s36 offen offset:2700
  buffer_load_ushort v30, v4, s[12:15], s36 offen offset:2700
  buffer_load_ushort v15, v4, s[4:7], s36 offen offset:3150
  buffer_load_ushort v31, v4, s[12:15], s36 offen offset:3150
  v_mov_b32 v36, -1
  v_mov_b32 v37, -1
  v_mov_b32 v38, -1
  v_mov_b32 v39, -1
  v_lshlrev_b32 v48, 4, v0
  v_mov_b32 v49, 2146435072
  s_cmp_lt_u32 s30, 224
  s_cselect_b64 vcc, -1, 0
  v_cndmask_b32 v48, v49, v48, vcc
  s_mul_i32 s65, s30, 8448
  s_add_u32 s65, s65, 4194304
  buffer_store_dwordx4 v[36:39], v48, s[8:11], s65 offen sc1
  s_add_u32 s65, s65, 4096
  buffer_store_dwordx4 v[36:39], v48, s[8:11], s65 offen sc1
  v_mov_b32 v50, 0
  s_lshl_b32 s66, s30, 2
  s_add_u32 s66, s66, 25165824
  v_lshlrev_b32 v51, 10, v0
  v_cmp_gt_u32 vcc, 4, v0
  s_nop 1
  v_cndmask_b32 v51, v49, v51, vcc
  buffer_store_dword v50, v51, s[8:11], s66 offen
  v_lshrrev_b32 v20, 4, v2
  v_and_b32 v21, 1, v20
  v_lshrrev_b32 v20, 1, v20
  v_bfe_u32 v22, v2, 2, 2
  v_and_b32 v23, 3, v2
  v_lshl_add_u32 v52, v20, 3, v22
  v_mul_u32_u24 v52, 224, v52
  v_lshl_add_u32 v52, v23, 3, v52
  v_mul_u32_u24 v53, 7296, v21
  v_add_u32 v52, v52, v53
  v_lshl_add_u32 v54, v20, 2, v22
  v_mul_u32_u24 v54, 448, v54
  v_lshl_add_u32 v54, v23, 3, v54
  v_lshl_add_u32 v54, v21, 5, v54
  v_add_u32 v54, 16384, v54
  v_lshlrev_b32 v55, 4, v2
  s_mul_i32 s67, s39, 196
  s_lshl_b32 s68, s38, 1
  s_add_u32 s67, s67, s68
  s_lshl_b32 s67, s67, 10
  s_add_u32 s67, s67, 10485760
  s_mul_i32 s69, s41, 784
  s_add_u32 s69, s69, s40
  s_lshl_b32 s69, s69, 10
  s_add_u32 s69, s69, 14680064
  s_cmp_eq_u32 s94, 0
  s_cselect_b32 s67, 2146435072, s67
  s_cmp_eq_u32 s95, 0
  s_cselect_b32 s69, 2146435072, s69
  s_add_u32 s54, s31, 0
  s_cmp_ge_u32 s54, 7
  s_cselect_b32 s55, 1, 0
  s_mul_i32 s56, s55, 7
  s_sub_u32 s56, s54, s56
  s_mul_i32 s57, s55, 3584
  s_lshl_b32 s58, s56, 5
  s_add_u32 s57, s57, s58
  v_add_u32 v104, s57, v52
  s_mul_i32 s86, s56, 28672
  s_lshl_b32 s58, s55, 10
  s_add_u32 s86, s86, s58
  s_add_u32 s86, s86, s67
  s_add_u32 s54, s31, 4
  s_cmp_ge_u32 s54, 7
  s_cselect_b32 s55, 1, 0
  s_mul_i32 s56, s55, 7
  s_sub_u32 s56, s54, s56
  s_mul_i32 s57, s55, 3584
  s_lshl_b32 s58, s56, 5
  s_add_u32 s57, s57, s58
  v_add_u32 v105, s57, v52
  s_mul_i32 s87, s56, 28672
  s_lshl_b32 s58, s55, 10
  s_add_u32 s87, s87, s58
  s_add_u32 s87, s87, s67
  s_add_u32 s54, s31, 8
  s_cmp_ge_u32 s54, 7
  s_cselect_b32 s55, 1, 0
  s_mul_i32 s56, s55, 7
  s_sub_u32 s56, s54, s56
  s_mul_i32 s57, s55, 3584
  s_lshl_b32 s58, s56, 5
  s_add_u32 s57, s57, s58
  v_add_u32 v106, s57, v52
  s_mul_i32 s88, s56, 28672
  s_lshl_b32 s58, s55, 10
  s_add_u32 s88, s88, s58
  s_add_u32 s88, s88, s67
  s_add_u32 s54, s31, 12
  s_cmp_ge_u32 s54, 7
  s_cselect_b32 s55, 1, 0
  s_mul_i32 s56, s55, 7
  s_sub_u32 s56, s54, s56
  s_mul_i32 s57, s55, 3584
  s_lshl_b32 s58, s56, 5
  s_add_u32 s57, s57, s58
  v_add_u32 v107, s57, v52
  s_mul_i32 s89, s56, 28672
  s_lshl_b32 s58, s55, 10
  s_add_u32 s89, s89, s58
  s_add_u32 s89, s89, s67
  s_cmp_ge_u32 s31, 2
  s_cselect_b32 s89, 2146435072, s89
  s_add_u32 s54, s31, 0
  s_lshl_b32 s57, s54, 6
  v_add_u32 v108, s57, v54
  s_mul_i32 s90, s54, 114688
  s_add_u32 s90, s90, s69
  s_add_u32 s54, s31, 4
  s_lshl_b32 s57, s54, 6
  v_add_u32 v109, s57, v54
  s_mul_i32 s91, s54, 114688
  s_add_u32 s91, s91, s69
  s_cmp_ge_u32 s31, 3
  s_cselect_b32 s91, 2146435072, s91
  v_add_u32 v82, 0, v0
  v_lshrrev_b32 v83, 3, v82
  v_and_b32 v84, 7, v82
  v_mul_u32_u24 v110, 144, v83
  v_lshl_add_u32 v110, v84, 4, v110
  v_add_u32 v83, s96, v83
  v_mul_u32_u24 v83, 8448, v83
  v_lshl_add_u32 v86, v84, 4, v83
  v_cmp_gt_u32 vcc, 448, v82
  v_mov_b32 v84, 2146435072
  s_nop 0
  v_cndmask_b32 v86, v84, v86, vcc
  v_add_u32 v82, 256, v0
  v_lshrrev_b32 v83, 3, v82
  v_and_b32 v84, 7, v82
  v_mul_u32_u24 v111, 144, v83
  v_lshl_add_u32 v111, v84, 4, v111
  v_add_u32 v83, s96, v83
  v_mul_u32_u24 v83, 8448, v83
  v_lshl_add_u32 v87, v84, 4, v83
  v_cmp_gt_u32 vcc, 448, v82
  v_mov_b32 v84, 2146435072
  s_nop 0
  v_cndmask_b32 v87, v84, v87, vcc
  s_lshl_b32 s98, s97, 7
  s_add_u32 s98, s98, 2097152
  s_waitcnt vmcnt(3)
  v_lshl_or_b32 v8, v24, 16, v8
  v_lshl_or_b32 v9, v25, 16, v9
  v_lshl_or_b32 v10, v26, 16, v10
  v_lshl_or_b32 v11, v27, 16, v11
  v_lshl_or_b32 v12, v28, 16, v12
  v_lshl_or_b32 v13, v29, 16, v13
  v_lshl_or_b32 v14, v30, 16, v14
  v_lshl_or_b32 v15, v31, 16, v15
  s_mov_b32 s59, 2097152
  v_mul_u32_u24 v80, 144, v2
  s_lshl_b32 s54, s31, 5
  v_add_u32 v80, s54, v80
  v_cmp_gt_u32 vcc, 56, v2
  v_mov_b32 v81, 8064
  s_nop 0
  v_cndmask_b32 v80, v81, v80, vcc
  ds_write_b128 v80, v[8:11] offset:24576
  ds_write_b128 v80, v[12:15] offset:24592
  s_waitcnt lgkmcnt(0)
  s_barrier
  ds_read_b128 v[96:99], v110 offset:24576
  ds_read_b128 v[100:103], v111 offset:24576
  ds_read_b64_tr_b16 v[56:57], v104
  ds_read_b64_tr_b16 v[58:59], v104 offset:896
  ds_read_b64_tr_b16 v[60:61], v105
  ds_read_b64_tr_b16 v[62:63], v105 offset:896
  ds_read_b64_tr_b16 v[64:65], v106
  ds_read_b64_tr_b16 v[66:67], v106 offset:896
  ds_read_b64_tr_b16 v[68:69], v107
  ds_read_b64_tr_b16 v[70:71], v107 offset:896
  ds_read_b64_tr_b16 v[72:73], v108
  ds_read_b64_tr_b16 v[74:75], v108 offset:3584
  ds_read_b64_tr_b16 v[76:77], v109
  ds_read_b64_tr_b16 v[78:79], v109 offset:3584
  s_waitcnt lgkmcnt(13)
  buffer_store_dwordx4 v[96:99], v86, s[8:11], s98 offen sc1
  s_waitcnt lgkmcnt(12)
  buffer_store_dwordx4 v[100:103], v87, s[8:11], s98 offen sc1
  s_waitcnt lgkmcnt(10)
  buffer_store_dwordx4 v[56:59], v55, s[8:11], s86 offen sc1
  s_waitcnt lgkmcnt(8)
  buffer_store_dwordx4 v[60:63], v55, s[8:11], s87 offen sc1
  s_waitcnt lgkmcnt(6)
  buffer_store_dwordx4 v[64:67], v55, s[8:11], s88 offen sc1
  s_waitcnt lgkmcnt(4)
  buffer_store_dwordx4 v[68:71], v55, s[8:11], s89 offen sc1
  s_waitcnt lgkmcnt(2)
  buffer_store_dwordx4 v[72:75], v55, s[8:11], s90 offen sc1
  s_waitcnt lgkmcnt(0)
  buffer_store_dwordx4 v[76:79], v55, s[8:11], s91 offen sc1
Lk1_end:
  s_endpgm
.globl k2_kernel
.p2align 8
.type k2_kernel,@function
k2_kernel:
  s_cmp_ge_u32 s2, 256
  s_cbranch_scc1 Lk2_end
  s_load_dwordx2 s[42:43], s[0:1], 72
  s_load_dwordx2 s[40:41], s[0:1], 0
  s_load_dwordx2 s[44:45], s[0:1], 56
  s_load_dwordx2 s[46:47], s[0:1], 48
  s_getreg_b32 s58, hwreg(HW_REG_XCC_ID)
  v_lshrrev_b32 v1, 6, v0
  v_and_b32 v0, 63, v0
  v_readfirstlane_b32 s23, v1
  v_lshlrev_b32 v252, 4, v0
  v_add_u32 v253, 0x10000, v252
  s_and_b32 s58, s58, 15
  s_add_u32 s58, s58, 1
  s_and_b32 s54, s2, 7
  s_lshr_b32 s55, s2, 3
  s_lshl_b32 s56, s54, 5
  s_add_u32 s56, s56, s55
  s_and_b32 s21, s55, 15
  s_min_u32 s20, s2, 223
  s_lshl_b32 s62, s56, 3
  v_and_b32 v1, 15, v0
  v_lshrrev_b32 v2, 4, v0
  v_lshlrev_b32 v3, 4, v0
  s_mul_i32 s24, s20, 8448
  s_lshl_b32 s26, s23, 11
  s_add_u32 s25, s24, s26
  s_add_u32 s25, s25, 0
  s_add_u32 s33, s26, 0
  s_add_u32 s34, s33, 1024
  s_add_u32 s35, s25, 1024
  s_lshl_b32 s27, s23, 6
  s_add_u32 s27, s27, s24
  s_add_u32 s27, s27, 2097152
  v_lshlrev_b32 v4, 2, v1
  v_lshl_add_u32 v4, v2, 10, v4
  s_add_u32 s28, s27, 4096
  s_mul_i32 s50, s21, 7
  s_lshl_b32 s51, s23, 1
  s_add_u32 s50, s50, s51
  s_mul_i32 s50, s50, 28672
  s_add_u32 s50, s50, 10485760
  s_add_u32 s51, s50, 28672
  s_cmp_eq_u32 s23, 3
  s_cselect_b32 s51, 2146435072, s51
  s_mov_b32 s10, 33554432
  s_mov_b32 s11, 0x20000
  s_waitcnt lgkmcnt(0)
  s_mov_b32 s8, s42
  s_and_b32 s9, s43, 0xffff
  s_cmp_ge_u32 s2, 224
  s_cbranch_scc1 Lk2_nop2
  s_mov_b32 m0, s33
  s_nop 0
  buffer_load_dwordx4 v3, s[8:11], s25 offen lds
  s_mov_b32 m0, s34
  s_nop 0
  buffer_load_dwordx4 v3, s[8:11], s35 offen lds
  buffer_load_dword v40, v4, s[8:11], s27 offen offset:0
  buffer_load_dword v41, v4, s[8:11], s27 offen offset:256
  buffer_load_dword v42, v4, s[8:11], s27 offen offset:512
  buffer_load_dword v43, v4, s[8:11], s27 offen offset:768
  buffer_load_dword v44, v4, s[8:11], s28 offen offset:0
  buffer_load_dword v45, v4, s[8:11], s28 offen offset:256
  buffer_load_dword v46, v4, s[8:11], s28 offen offset:512
  buffer_load_dword v47, v4, s[8:11], s28 offen offset:768
  s_mov_b32 s4, s40
  s_and_b32 s5, s41, 0xffff
  s_mov_b32 s6, 1835008
  s_mov_b32 s7, 0x20000
  s_mov_b32 s12, s44
  s_and_b32 s13, s45, 0xffff
  s_mov_b32 s14, 1835008
  s_mov_b32 s15, 0x20000
  s_cmp_lg_u32 s23, 3
  s_cbranch_scc1 Lk2_notbla
  s_lshl_b32 s36, s56, 2
  s_add_u32 s36, s36, 25165824
  v_mov_b32 v246, s58
  v_mov_b32 v247, 0
  s_mov_b64 exec, 1
  buffer_store_dword v246, v247, s[8:11], s36 offen sc1
  s_mov_b64 exec, -1
Lk2_notbla:
  v_and_b32 v240, 15, v0
  v_lshrrev_b32 v243, 4, v0
  v_lshrrev_b32 v242, 2, v240
  v_and_b32 v241, 3, v240
  v_add_u32 v239, s62, v241
  v_mul_u32_u24 v239, 896, v239
  s_lshl_b32 s25, s23, 5
  v_lshl_add_u32 v239, v243, 3, v239
  v_add_u32 v239, s25, v239
  v_lshl_add_u32 v236, v242, 7, v239
  v_sub_u32 v238, 7, v242
  v_lshl_add_u32 v237, v238, 7, v239
  v_cmp_eq_u32 vcc, 0, v242
  v_mov_b32 v238, 2146435072
  s_nop 0
  v_cndmask_b32 v237, v237, v238, vcc
  v_cndmask_b32 v238, 1.0, 0, vcc
  buffer_load_dwordx2 v[228:229], v236, s[4:7], 0 offen offset:0
  buffer_load_dwordx2 v[230:231], v237, s[4:7], 0 offen offset:0
  buffer_load_dwordx2 v[232:233], v236, s[4:7], 0 offen offset:3584
  buffer_load_dwordx2 v[234:235], v237, s[4:7], 0 offen offset:3584
  s_lshr_b32 s28, s62, 5
  s_mul_i32 s28, s28, 28672
  s_and_b32 s29, s62, 31
  s_lshl_b32 s29, s29, 4
  s_add_u32 s28, s28, s29
  s_add_u32 s28, s28, 8388608
  s_lshl_b32 s29, s23, 6
  v_add_u32 v244, s29, v0
  v_lshrrev_b32 v245, 3, v244
  v_and_b32 v246, 7, v244
  v_lshlrev_b32 v246, 4, v246
  v_lshl_add_u32 v245, v245, 9, v246
  v_add_u32 v246, 16384, v245
  v_cmp_gt_u32 vcc, 192, v244
  v_mov_b32 v247, 2146435072
  s_nop 0
  v_cndmask_b32 v246, v247, v246, vcc
  buffer_load_dwordx4 v[248:251], v245, s[8:11], s28 offen sc1
  buffer_load_dwordx4 v[248:251], v246, s[8:11], s28 offen sc1
  s_lshl_b32 s29, s23, 4
  v_add_u32 v5, s29, v1
  v_cvt_f32_u32 v6, v5
  v_mul_f32 v128, 0x3c800000, v6
  v_cvt_f32_u32 v7, v2
  v_mul_f32 v129, 0x41000000, v7
  v_mul_f32 v129, v129, v128
  v_and_b32 v131, 1, v5
  v_mul_u32_u24 v131, 0x8000, v131
  v_lshl_or_b32 v131, v131, 16, v131
  v_mov_b32 v140, v129
  v_add_f32 v141, v129, v128
  v_add_f32 v150, v128, v128
  v_cos_f32 v154, v140
  v_cos_f32 v155, v141
  v_sin_f32 v156, v140
  v_sin_f32 v157, v141
  v_cos_f32 v142, v150
  v_sin_f32 v144, v150
  s_nop 0
  v_pk_mul_f32 v[150:151], v[156:157], v[144:145] op_sel_hi:[1,0]
  v_pk_mul_f32 v[152:153], v[154:155], v[144:145] op_sel_hi:[1,0]
  v_pk_fma_f32 v[158:159], v[154:155], v[142:143], v[150:151] op_sel_hi:[1,0,1] neg_lo:[0,0,1] neg_hi:[0,0,1]
  v_pk_fma_f32 v[160:161], v[156:157], v[142:143], v[152:153] op_sel_hi:[1,0,1]
  v_pk_mul_f32 v[150:151], v[160:161], v[144:145] op_sel_hi:[1,0]
  v_pk_mul_f32 v[152:153], v[158:159], v[144:145] op_sel_hi:[1,0]
  v_pk_fma_f32 v[162:163], v[158:159], v[142:143], v[150:151] op_sel_hi:[1,0,1] neg_lo:[0,0,1] neg_hi:[0,0,1]
  v_pk_fma_f32 v[164:165], v[160:161], v[142:143], v[152:153] op_sel_hi:[1,0,1]
  v_pk_mul_f32 v[150:151], v[164:165], v[144:145] op_sel_hi:[1,0]
  v_pk_mul_f32 v[152:153], v[162:163], v[144:145] op_sel_hi:[1,0]
  v_pk_fma_f32 v[166:167], v[162:163], v[142:143], v[150:151] op_sel_hi:[1,0,1] neg_lo:[0,0,1] neg_hi:[0,0,1]
  v_pk_fma_f32 v[168:169], v[164:165], v[142:143], v[152:153] op_sel_hi:[1,0,1]
  v_cvt_pk_bf16_f32 v48, v154, v155
  v_cvt_pk_bf16_f32 v56, v156, v157
  v_xor_b32 v64, 0x80008000, v56
  v_xor_b32 v52, v131, v48
  v_xor_b32 v60, v131, v56
  v_xor_b32 v68, v131, v64
  v_cvt_pk_bf16_f32 v49, v158, v159
  v_cvt_pk_bf16_f32 v57, v160, v161
  v_xor_b32 v65, 0x80008000, v57
  v_xor_b32 v53, v131, v49
  v_xor_b32 v61, v131, v57
  v_xor_b32 v69, v131, v65
  v_cvt_pk_bf16_f32 v50, v162, v163
  v_cvt_pk_bf16_f32 v58, v164, v165
  v_xor_b32 v66, 0x80008000, v58
  v_xor_b32 v54, v131, v50
  v_xor_b32 v62, v131, v58
  v_xor_b32 v70, v131, v66
  v_cvt_pk_bf16_f32 v51, v166, v167
  v_cvt_pk_bf16_f32 v59, v168, v169
  v_xor_b32 v67, 0x80008000, v59
  v_xor_b32 v55, v131, v51
  v_xor_b32 v63, v131, v59
  v_xor_b32 v71, v131, v67
  v_cvt_f32_u32 v130, v1
  v_mul_f32 v128, 0x3d000000, v130
  v_mul_f32 v129, 4.0, v7
  v_mul_f32 v129, v129, v128
  v_mov_b32 v140, v129
  v_add_f32 v141, v129, v128
  v_add_f32 v150, v128, v128
  v_cos_f32 v154, v140
  v_cos_f32 v155, v141
  v_sin_f32 v156, v140
  v_sin_f32 v157, v141
  v_cos_f32 v142, v150
  v_sin_f32 v144, v150
  s_nop 0
  v_pk_mul_f32 v[150:151], v[156:157], v[144:145] op_sel_hi:[1,0]
  v_pk_mul_f32 v[152:153], v[154:155], v[144:145] op_sel_hi:[1,0]
  v_pk_fma_f32 v[158:159], v[154:155], v[142:143], v[150:151] op_sel_hi:[1,0,1] neg_lo:[0,0,1] neg_hi:[0,0,1]
  v_pk_fma_f32 v[160:161], v[156:157], v[142:143], v[152:153] op_sel_hi:[1,0,1]
  v_cvt_pk_bf16_f32 v72, v154, v155
  v_cvt_pk_bf16_f32 v80, v156, v157
  v_xor_b32 v88, 0x80008000, v80
  v_xor_b32 v74, v131, v72
  v_xor_b32 v82, v131, v80
  v_xor_b32 v90, v131, v88
  v_cvt_pk_bf16_f32 v73, v158, v159
  v_cvt_pk_bf16_f32 v81, v160, v161
  v_xor_b32 v89, 0x80008000, v81
  v_xor_b32 v75, v131, v73
  v_xor_b32 v83, v131, v81
  v_xor_b32 v91, v131, v89
  v_xor_b32 v76, 0x80000000, v72
  v_xor_b32 v77, 0x80000000, v73
  v_xor_b32 v78, 0x80000000, v74
  v_xor_b32 v79, 0x80000000, v75
  v_xor_b32 v84, 0x80000000, v80
  v_xor_b32 v85, 0x80000000, v81
  v_xor_b32 v86, 0x80000000, v82
  v_xor_b32 v87, 0x80000000, v83
  v_xor_b32 v92, 0x80000000, v88
  v_xor_b32 v93, 0x80000000, v89
  v_xor_b32 v94, 0x80000000, v90
  v_xor_b32 v95, 0x80000000, v91
  v_mul_f32 v128, 0xba000000, v6
  v_mul_f32 v129, 4.0, v7
  v_mul_f32 v129, v129, v128
  v_add_f32 v141, v129, v128
  v_add_f32 v140, v128, v128
  v_cos_f32 v96, v129
  v_cos_f32 v97, v141
  v_sin_f32 v104, v129
  v_sin_f32 v105, v141
  v_cos_f32 v142, v140
  v_sin_f32 v144, v140
  s_nop 0
  v_pk_mul_f32 v[146:147], v[104:105], v[144:145] op_sel_hi:[1,0]
  v_pk_mul_f32 v[148:149], v[96:97], v[144:145] op_sel_hi:[1,0]
  v_pk_fma_f32 v[98:99], v[96:97], v[142:143], v[146:147] op_sel_hi:[1,0,1] neg_lo:[0,0,1] neg_hi:[0,0,1]
  v_pk_fma_f32 v[106:107], v[104:105], v[142:143], v[148:149] op_sel_hi:[1,0,1]
  v_mul_f32 v140, 0x41800000, v128
  v_cos_f32 v142, v140
  v_sin_f32 v144, v140
  s_nop 0
  v_pk_mul_f32 v[146:147], v[104:105], v[144:145] op_sel_hi:[1,0]
  v_pk_mul_f32 v[148:149], v[96:97], v[144:145] op_sel_hi:[1,0]
  v_pk_fma_f32 v[100:101], v[96:97], v[142:143], v[146:147] op_sel_hi:[1,0,1] neg_lo:[0,0,1] neg_hi:[0,0,1]
  v_pk_fma_f32 v[108:109], v[104:105], v[142:143], v[148:149] op_sel_hi:[1,0,1]
  v_pk_mul_f32 v[146:147], v[106:107], v[144:145] op_sel_hi:[1,0]
  v_pk_mul_f32 v[148:149], v[98:99], v[144:145] op_sel_hi:[1,0]
  v_pk_fma_f32 v[102:103], v[98:99], v[142:143], v[146:147] op_sel_hi:[1,0,1] neg_lo:[0,0,1] neg_hi:[0,0,1]
  v_pk_fma_f32 v[110:111], v[106:107], v[142:143], v[148:149] op_sel_hi:[1,0,1]
  s_mov_b32 s30, 0x36124925
  s_cmp_eq_u32 s20, 223
  s_cselect_b32 s30, 0x35924925, s30
  s_mov_b32 s31, s30
  v_cvt_f32_u32 v130, s29
  v_fmac_f32 v130, 4.0, v7
  v_add_u32 v128, 0, v1
  v_cvt_f32_u32 v128, v128
  v_mul_f32 v128, 0x3a000000, v128
  v_mul_f32 v129, v130, v128
  v_add_f32 v141, v129, v128
  v_add_f32 v140, v128, v128
  v_cos_f32 v112, v129
  v_cos_f32 v113, v141
  v_sin_f32 v132, v129
  v_sin_f32 v133, v141
  v_cos_f32 v142, v140
  v_sin_f32 v144, v140
  s_nop 0
  v_pk_mul_f32 v[146:147], v[132:133], v[144:145] op_sel_hi:[1,0]
  v_pk_mul_f32 v[148:149], v[112:113], v[144:145] op_sel_hi:[1,0]
  v_pk_fma_f32 v[114:115], v[112:113], v[142:143], v[146:147] op_sel_hi:[1,0,1] neg_lo:[0,0,1] neg_hi:[0,0,1]
  v_pk_fma_f32 v[134:135], v[132:133], v[142:143], v[148:149] op_sel_hi:[1,0,1]
  v_pk_mul_f32 v[112:113], v[112:113], s[30:31]
  v_pk_mul_f32 v[132:133], v[132:133], s[30:31]
  v_pk_mul_f32 v[114:115], v[114:115], s[30:31]
  v_pk_mul_f32 v[134:135], v[134:135], s[30:31]
  v_add_u32 v128, 16, v1
  v_cvt_f32_u32 v128, v128
  v_mul_f32 v128, 0x3a000000, v128
  v_mul_f32 v129, v130, v128
  v_add_f32 v141, v129, v128
  v_add_f32 v140, v128, v128
  v_cos_f32 v116, v129
  v_cos_f32 v117, v141
  v_sin_f32 v136, v129
  v_sin_f32 v137, v141
  v_cos_f32 v142, v140
  v_sin_f32 v144, v140
  s_nop 0
  v_pk_mul_f32 v[146:147], v[136:137], v[144:145] op_sel_hi:[1,0]
  v_pk_mul_f32 v[148:149], v[116:117], v[144:145] op_sel_hi:[1,0]
  v_pk_fma_f32 v[118:119], v[116:117], v[142:143], v[146:147] op_sel_hi:[1,0,1] neg_lo:[0,0,1] neg_hi:[0,0,1]
  v_pk_fma_f32 v[138:139], v[136:137], v[142:143], v[148:149] op_sel_hi:[1,0,1]
  v_pk_mul_f32 v[116:117], v[116:117], s[30:31]
  v_pk_mul_f32 v[136:137], v[136:137], s[30:31]
  v_pk_mul_f32 v[118:119], v[118:119], s[30:31]
  v_pk_mul_f32 v[138:139], v[138:139], s[30:31]
  v_xor_b32 v128, v1, v2
  v_lshlrev_b32 v128, 4, v128
  v_lshl_add_u32 v128, v1, 8, v128
  v_xor_b32 v129, 64, v128
  v_xor_b32 v130, 128, v128
  v_xor_b32 v131, 192, v128
  s_waitcnt vmcnt(14)
  s_barrier
  ds_read_b128 v[8:11], v128 offset:0
  ds_read_b128 v[12:15], v129 offset:0
  ds_read_b128 v[16:19], v130 offset:0
  ds_read_b128 v[20:23], v131 offset:0
  buffer_load_dwordx4 a[0:3], v252, s[8:11], s50 offen offset:0
  ds_read_b128 v[24:27], v128 offset:4096
  ds_read_b128 v[28:31], v129 offset:4096
  ds_read_b128 v[32:35], v130 offset:4096
  ds_read_b128 v[36:39], v131 offset:4096
  s_waitcnt lgkmcnt(7)
  v_mfma_f32_16x16x32_bf16 v[140:143], v[8:11], v[48:51], 0
  s_waitcnt lgkmcnt(6)
  v_mfma_f32_16x16x32_bf16 v[144:147], v[12:15], v[48:51], 0
  s_waitcnt lgkmcnt(5)
  v_mfma_f32_16x16x32_bf16 v[140:143], v[16:19], v[52:55], v[140:143]
  s_waitcnt lgkmcnt(4)
  v_mfma_f32_16x16x32_bf16 v[144:147], v[20:23], v[52:55], v[144:147]
  buffer_load_dwordx4 a[4:7], v252, s[8:11], s50 offen offset:1024
  v_mfma_f32_16x16x32_bf16 v[140:143], v[12:15], v[56:59], v[140:143]
  v_mfma_f32_16x16x32_bf16 v[144:147], v[8:11], v[64:67], v[144:147]
  v_mfma_f32_16x16x32_bf16 v[140:143], v[20:23], v[60:63], v[140:143]
  v_mfma_f32_16x16x32_bf16 v[144:147], v[16:19], v[68:71], v[144:147]
  s_waitcnt lgkmcnt(3)
  v_mfma_f32_16x16x32_bf16 v[148:151], v[24:27], v[48:51], 0
  s_waitcnt lgkmcnt(2)
  v_mfma_f32_16x16x32_bf16 v[152:155], v[28:31], v[48:51], 0
  s_waitcnt lgkmcnt(1)
  v_mfma_f32_16x16x32_bf16 v[148:151], v[32:35], v[52:55], v[148:151]
  buffer_load_dwordx4 a[8:11], v252, s[8:11], s50 offen offset:2048
  s_waitcnt lgkmcnt(0)
  v_mfma_f32_16x16x32_bf16 v[152:155], v[36:39], v[52:55], v[152:155]
  v_mfma_f32_16x16x32_bf16 v[148:151], v[28:31], v[56:59], v[148:151]
  v_mfma_f32_16x16x32_bf16 v[152:155], v[24:27], v[64:67], v[152:155]
  v_mfma_f32_16x16x32_bf16 v[148:151], v[36:39], v[60:63], v[148:151]
  v_mfma_f32_16x16x32_bf16 v[152:155], v[32:35], v[68:71], v[152:155]
  v_pk_mul_f32 v[124:125], v[144:145], v[104:105]
  v_pk_mul_f32 v[126:127], v[140:141], v[104:105]
  v_pk_fma_f32 v[140:141], v[140:141], v[96:97], v[124:125] neg_lo:[0,0,1] neg_hi:[0,0,1]
  v_pk_fma_f32 v[144:145], v[144:145], v[96:97], v[126:127]
  v_pk_mul_f32 v[124:125], v[146:147], v[106:107]
  v_pk_mul_f32 v[126:127], v[142:143], v[106:107]
  buffer_load_dwordx4 a[12:15], v252, s[8:11], s50 offen offset:3072
  v_pk_fma_f32 v[142:143], v[142:143], v[98:99], v[124:125] neg_lo:[0,0,1] neg_hi:[0,0,1]
  v_pk_fma_f32 v[146:147], v[146:147], v[98:99], v[126:127]
  v_cvt_pk_bf16_f32 v156, v140, v141
  v_cvt_pk_bf16_f32 v160, v144, v145
  v_cvt_pk_bf16_f32 v157, v142, v143
  v_cvt_pk_bf16_f32 v161, v146, v147
  v_pk_mul_f32 v[124:125], v[152:153], v[108:109]
  v_pk_mul_f32 v[126:127], v[148:149], v[108:109]
  v_pk_fma_f32 v[148:149], v[148:149], v[100:101], v[124:125] neg_lo:[0,0,1] neg_hi:[0,0,1]
  v_pk_fma_f32 v[152:153], v[152:153], v[100:101], v[126:127]
  v_pk_mul_f32 v[124:125], v[154:155], v[110:111]
  v_pk_mul_f32 v[126:127], v[150:151], v[110:111]
  v_pk_fma_f32 v[150:151], v[150:151], v[102:103], v[124:125] neg_lo:[0,0,1] neg_hi:[0,0,1]
  v_pk_fma_f32 v[154:155], v[154:155], v[102:103], v[126:127]
  v_cvt_pk_bf16_f32 v158, v148, v149
  v_cvt_pk_bf16_f32 v162, v152, v153
  v_cvt_pk_bf16_f32 v159, v150, v151
  v_cvt_pk_bf16_f32 v163, v154, v155
  s_nop 0
  v_mfma_f32_16x16x32_bf16 v[164:167], v[72:75], v[156:159], 0
  v_mfma_f32_16x16x32_bf16 v[168:171], v[72:75], v[160:163], 0
  v_mfma_f32_16x16x32_bf16 v[164:167], v[80:83], v[160:163], v[164:167]
  s_add_u32 s50, s50, 4096
  buffer_load_dwordx4 a[16:19], v252, s[8:11], s50 offen offset:0
  v_mfma_f32_16x16x32_bf16 v[168:171], v[88:91], v[156:159], v[168:171]
  v_mfma_f32_16x16x32_bf16 v[172:175], v[76:79], v[156:159], 0
  v_mfma_f32_16x16x32_bf16 v[176:179], v[76:79], v[160:163], 0
  v_mfma_f32_16x16x32_bf16 v[172:175], v[84:87], v[160:163], v[172:175]
  v_mfma_f32_16x16x32_bf16 v[176:179], v[92:95], v[156:159], v[176:179]
  s_waitcnt vmcnt(18)
  v_lshlrev_b32 v180, 16, v40
  v_and_b32 v188, 0xffff0000, v40
  s_waitcnt vmcnt(17)
  v_lshlrev_b32 v181, 16, v41
  v_and_b32 v189, 0xffff0000, v41
  s_waitcnt vmcnt(16)
  v_lshlrev_b32 v182, 16, v42
  v_and_b32 v190, 0xffff0000, v42
  s_waitcnt vmcnt(15)
  v_lshlrev_b32 v183, 16, v43
  v_and_b32 v191, 0xffff0000, v43
  buffer_load_dwordx4 a[20:23], v252, s[8:11], s50 offen offset:1024
  s_waitcnt vmcnt(15)
  v_lshlrev_b32 v184, 16, v44
  v_and_b32 v192, 0xffff0000, v44
  s_waitcnt vmcnt(14)
  v_lshlrev_b32 v185, 16, v45
  v_and_b32 v193, 0xffff0000, v45
  s_waitcnt vmcnt(13)
  v_lshlrev_b32 v186, 16, v46
  v_and_b32 v194, 0xffff0000, v46
  s_waitcnt vmcnt(12)
  v_lshlrev_b32 v187, 16, v47
  v_and_b32 v195, 0xffff0000, v47
  v_pk_mul_f32 v[124:125], v[168:169], v[188:189]
  v_pk_mul_f32 v[126:127], v[164:165], v[188:189]
  v_pk_fma_f32 v[164:165], v[164:165], v[180:181], v[124:125] neg_lo:[0,0,1] neg_hi:[0,0,1]
  v_pk_fma_f32 v[168:169], v[168:169], v[180:181], v[126:127]
  v_pk_mul_f32 v[124:125], v[170:171], v[190:191]
  v_pk_mul_f32 v[126:127], v[166:167], v[190:191]
  v_pk_fma_f32 v[166:167], v[166:167], v[182:183], v[124:125] neg_lo:[0,0,1] neg_hi:[0,0,1]
  v_pk_fma_f32 v[170:171], v[170:171], v[182:183], v[126:127]
  v_cvt_pk_bf16_f32 v196, v164, v165
  v_cvt_pk_bf16_f32 v200, v168, v169
  v_cvt_pk_bf16_f32 v197, v166, v167
  v_cvt_pk_bf16_f32 v201, v170, v171
  v_pk_mul_f32 v[124:125], v[176:177], v[192:193]
  v_pk_mul_f32 v[126:127], v[172:173], v[192:193]
  v_pk_fma_f32 v[172:173], v[172:173], v[184:185], v[124:125] neg_lo:[0,0,1] neg_hi:[0,0,1]
  v_pk_fma_f32 v[176:177], v[176:177], v[184:185], v[126:127]
  v_pk_mul_f32 v[124:125], v[178:179], v[194:195]
  v_pk_mul_f32 v[126:127], v[174:175], v[194:195]
  v_pk_fma_f32 v[174:175], v[174:175], v[186:187], v[124:125] neg_lo:[0,0,1] neg_hi:[0,0,1]
  v_pk_fma_f32 v[178:179], v[178:179], v[186:187], v[126:127]
  v_cvt_pk_bf16_f32 v198, v172, v173
  buffer_load_dwordx4 a[24:27], v252, s[8:11], s50 offen offset:2048
  v_cvt_pk_bf16_f32 v202, v176, v177
  v_cvt_pk_bf16_f32 v199, v174, v175
  v_cvt_pk_bf16_f32 v203, v178, v179
  s_nop 0
  v_mfma_f32_16x16x32_bf16 v[204:207], v[196:199], v[72:75], 0
  v_mfma_f32_16x16x32_bf16 v[208:211], v[196:199], v[80:83], 0
  v_mfma_f32_16x16x32_bf16 v[204:207], v[200:203], v[88:91], v[204:207]
  v_mfma_f32_16x16x32_bf16 v[208:211], v[200:203], v[72:75], v[208:211]
  v_mfma_f32_16x16x32_bf16 v[212:215], v[196:199], v[76:79], 0
  v_mfma_f32_16x16x32_bf16 v[216:219], v[196:199], v[84:87], 0
  v_mfma_f32_16x16x32_bf16 v[212:215], v[200:203], v[92:95], v[212:215]
  buffer_load_dwordx4 a[28:31], v252, s[8:11], s50 offen offset:3072
  v_mfma_f32_16x16x32_bf16 v[216:219], v[200:203], v[76:79], v[216:219]
  v_mul_u32_u24 v128, 272, v1
  v_lshl_add_u32 v129, v2, 3, v128
  s_lshl_b32 s31, s23, 5
  v_add_u32 v129, s31, v129
  v_lshl_add_u32 v130, v2, 4, v128
  v_pk_mul_f32 v[124:125], v[208:209], v[132:133]
  v_pk_mul_f32 v[126:127], v[204:205], v[132:133]
  v_pk_fma_f32 v[204:205], v[204:205], v[112:113], v[124:125] neg_lo:[0,0,1] neg_hi:[0,0,1]
  v_pk_fma_f32 v[208:209], v[208:209], v[112:113], v[126:127]
  v_pk_mul_f32 v[124:125], v[210:211], v[134:135]
  v_pk_mul_f32 v[126:127], v[206:207], v[134:135]
  v_pk_fma_f32 v[206:207], v[206:207], v[114:115], v[124:125] neg_lo:[0,0,1] neg_hi:[0,0,1]
  v_pk_fma_f32 v[210:211], v[210:211], v[114:115], v[126:127]
  v_cvt_pk_bf16_f32 v220, v204, v205
  v_cvt_pk_bf16_f32 v221, v206, v207
  ds_write_b64 v129, v[220:221] offset:8192
  v_cvt_pk_bf16_f32 v222, v208, v209
  v_cvt_pk_bf16_f32 v223, v210, v211
  ds_write_b64 v129, v[222:223] offset:8320
  s_add_u32 s50, s50, 4096
  buffer_load_dwordx4 a[32:35], v252, s[8:11], s50 offen offset:0
  v_pk_mul_f32 v[124:125], v[216:217], v[136:137]
  v_pk_mul_f32 v[126:127], v[212:213], v[136:137]
  v_pk_fma_f32 v[212:213], v[212:213], v[116:117], v[124:125] neg_lo:[0,0,1] neg_hi:[0,0,1]
  v_pk_fma_f32 v[216:217], v[216:217], v[116:117], v[126:127]
  v_pk_mul_f32 v[124:125], v[218:219], v[138:139]
  v_pk_mul_f32 v[126:127], v[214:215], v[138:139]
  v_pk_fma_f32 v[214:215], v[214:215], v[118:119], v[124:125] neg_lo:[0,0,1] neg_hi:[0,0,1]
  v_pk_fma_f32 v[218:219], v[218:219], v[118:119], v[126:127]
  v_cvt_pk_bf16_f32 v224, v212, v213
  v_cvt_pk_bf16_f32 v225, v214, v215
  ds_write_b64 v129, v[224:225] offset:12544
  v_cvt_pk_bf16_f32 v226, v216, v217
  v_cvt_pk_bf16_f32 v227, v218, v219
  ds_write_b64 v129, v[226:227] offset:12672
  s_waitcnt lgkmcnt(0)
  buffer_load_dwordx4 a[36:39], v252, s[8:11], s50 offen offset:1024
  s_barrier
  ds_read_b128 v[8:11], v130 offset:8192
  ds_read_b128 v[12:15], v130 offset:8320
  buffer_load_dwordx4 a[40:43], v252, s[8:11], s50 offen offset:2048
  ds_read_b128 v[16:19], v130 offset:8256
  ds_read_b128 v[20:23], v130 offset:8384
  ds_read_b128 v[24:27], v130 offset:12544
  ds_read_b128 v[28:31], v130 offset:12672
  ds_read_b128 v[32:35], v130 offset:12608
  ds_read_b128 v[36:39], v130 offset:12736
  v_lshlrev_b32 v128, 7, v5
  buffer_load_dwordx4 a[44:47], v252, s[8:11], s50 offen offset:3072
  v_lshl_add_u32 v128, v2, 4, v128
  s_mul_i32 s31, s20, 8448
  s_add_u32 s31, s31, 4194304
  s_waitcnt lgkmcnt(7)
  v_mfma_f32_16x16x32_bf16 v[140:143], v[8:11], v[48:51], 0
  v_mfma_f32_16x16x32_bf16 v[144:147], v[8:11], v[56:59], 0
  s_waitcnt lgkmcnt(5)
  v_mfma_f32_16x16x32_bf16 v[140:143], v[16:19], v[52:55], v[140:143]
  v_mfma_f32_16x16x32_bf16 v[144:147], v[16:19], v[60:63], v[144:147]
  v_mfma_f32_16x16x32_bf16 v[140:143], v[12:15], v[64:67], v[140:143]
  v_mfma_f32_16x16x32_bf16 v[144:147], v[12:15], v[48:51], v[144:147]
  s_waitcnt lgkmcnt(4)
  v_mfma_f32_16x16x32_bf16 v[140:143], v[20:23], v[68:71], v[140:143]
  s_add_u32 s50, s50, 4096
  buffer_load_dwordx4 a[48:51], v252, s[8:11], s50 offen offset:0
  v_mfma_f32_16x16x32_bf16 v[144:147], v[20:23], v[52:55], v[144:147]
  s_waitcnt lgkmcnt(3)
  v_mfma_f32_16x16x32_bf16 v[148:151], v[24:27], v[48:51], 0
  v_mfma_f32_16x16x32_bf16 v[152:155], v[24:27], v[56:59], 0
  s_waitcnt lgkmcnt(1)
  v_mfma_f32_16x16x32_bf16 v[148:151], v[32:35], v[52:55], v[148:151]
  v_mfma_f32_16x16x32_bf16 v[152:155], v[32:35], v[60:63], v[152:155]
  v_mfma_f32_16x16x32_bf16 v[148:151], v[28:31], v[64:67], v[148:151]
  v_mfma_f32_16x16x32_bf16 v[152:155], v[28:31], v[48:51], v[152:155]
  buffer_load_dwordx4 a[52:55], v252, s[8:11], s50 offen offset:1024
  s_waitcnt lgkmcnt(0)
  v_mfma_f32_16x16x32_bf16 v[148:151], v[36:39], v[68:71], v[148:151]
  v_mfma_f32_16x16x32_bf16 v[152:155], v[36:39], v[52:55], v[152:155]
  v_cvt_pk_bf16_f32 v156, v140, v141
  v_cvt_pk_bf16_f32 v157, v142, v143
  v_cvt_pk_bf16_f32 v158, v144, v145
  v_cvt_pk_bf16_f32 v159, v146, v147
  s_nop 2
  v_cvt_pk_bf16_f32 v160, v148, v149
  v_cvt_pk_bf16_f32 v161, v150, v151
  v_cvt_pk_bf16_f32 v162, v152, v153
  v_cvt_pk_bf16_f32 v163, v154, v155
  v_mov_b32_dpp v164, v160 row_ror:8 row_mask:0xf bank_mask:0xf
  v_mov_b32_dpp v165, v161 row_ror:8 row_mask:0xf bank_mask:0xf
  v_mov_b32_dpp v166, v162 row_ror:8 row_mask:0xf bank_mask:0xf
  v_mov_b32_dpp v167, v163 row_ror:8 row_mask:0xf bank_mask:0xf
  v_cmp_gt_u32 vcc, 8, v1
  s_nop 1
  v_cndmask_b32 v168, v164, v156, vcc
  v_cndmask_b32 v172, v156, v164, vcc
  v_cndmask_b32 v169, v165, v157, vcc
  v_cndmask_b32 v173, v157, v165, vcc
  v_cndmask_b32 v170, v166, v158, vcc
  v_cndmask_b32 v174, v158, v166, vcc
  v_cndmask_b32 v171, v167, v159, vcc
  v_cndmask_b32 v175, v159, v167, vcc
  v_subrev_u32 v176, 960, v128
  v_add_u32 v177, 1088, v128
  v_cndmask_b32 v176, v176, v128, vcc
  v_cndmask_b32 v177, v128, v177, vcc
  buffer_store_dwordx4 v[168:171], v176, s[8:11], s31 offen sc1
  buffer_store_dwordx4 v[172:175], v177, s[8:11], s31 offen sc1
  s_branch Lk2_p3
Lk2_nop2:
  s_mov_b32 s4, s40
  s_and_b32 s5, s41, 0xffff
  s_mov_b32 s6, 1835008
  s_mov_b32 s7, 0x20000
  s_mov_b32 s12, s44
  s_and_b32 s13, s45, 0xffff
  s_mov_b32 s14, 1835008
  s_mov_b32 s15, 0x20000
  s_cmp_lg_u32 s23, 3
  s_cbranch_scc1 Lk2_notblb
  s_lshl_b32 s36, s56, 2
  s_add_u32 s36, s36, 25165824
  v_mov_b32 v246, s58
  v_mov_b32 v247, 0
  s_mov_b64 exec, 1
  buffer_store_dword v246, v247, s[8:11], s36 offen sc1
  s_mov_b64 exec, -1
Lk2_notblb:
  v_and_b32 v240, 15, v0
  v_lshrrev_b32 v243, 4, v0
  v_lshrrev_b32 v242, 2, v240
  v_and_b32 v241, 3, v240
  v_add_u32 v239, s62, v241
  v_mul_u32_u24 v239, 896, v239
  s_lshl_b32 s25, s23, 5
  v_lshl_add_u32 v239, v243, 3, v239
  v_add_u32 v239, s25, v239
  v_lshl_add_u32 v236, v242, 7, v239
  v_sub_u32 v238, 7, v242
  v_lshl_add_u32 v237, v238, 7, v239
  v_cmp_eq_u32 vcc, 0, v242
  v_mov_b32 v238, 2146435072
  s_nop 0
  v_cndmask_b32 v237, v237, v238, vcc
  v_cndmask_b32 v238, 1.0, 0, vcc
  s_waitcnt vmcnt(21)
  buffer_load_dwordx2 v[228:229], v236, s[4:7], 0 offen offset:0
  s_waitcnt vmcnt(21)
  buffer_load_dwordx2 v[230:231], v237, s[4:7], 0 offen offset:0
  s_waitcnt vmcnt(21)
  buffer_load_dwordx2 v[232:233], v236, s[4:7], 0 offen offset:3584
  s_waitcnt vmcnt(21)
  buffer_load_dwordx2 v[234:235], v237, s[4:7], 0 offen offset:3584
  s_lshr_b32 s28, s62, 5
  s_mul_i32 s28, s28, 28672
  s_and_b32 s29, s62, 31
  s_lshl_b32 s29, s29, 4
  s_add_u32 s28, s28, s29
  s_add_u32 s28, s28, 8388608
  s_lshl_b32 s29, s23, 6
  v_add_u32 v244, s29, v0
  v_lshrrev_b32 v245, 3, v244
  v_and_b32 v246, 7, v244
  v_lshlrev_b32 v246, 4, v246
  v_lshl_add_u32 v245, v245, 9, v246
  v_add_u32 v246, 16384, v245
  v_cmp_gt_u32 vcc, 192, v244
  v_mov_b32 v247, 2146435072
  s_nop 0
  v_cndmask_b32 v246, v247, v246, vcc
  buffer_load_dwordx4 v[248:251], v245, s[8:11], s28 offen sc1
  buffer_load_dwordx4 v[248:251], v246, s[8:11], s28 offen sc1
  s_lshl_b32 s24, s56, 5
  s_add_u32 s24, s24, 5132032
  v_mov_b32 v1, 0
  s_mov_b32 s25, 0
Lk2_idle:
  s_sleep 8
  buffer_load_dword v2, v1, s[8:11], s24 offen sc1
  s_waitcnt vmcnt(0)
  v_cmp_eq_u32 vcc, -1, v2
  s_add_u32 s25, s25, 1
  s_cmp_ge_u32 s25, 5000
  s_cbranch_scc1 Lk2_idledone
  s_nop 1
  s_cbranch_vccnz Lk2_idle
Lk2_idledone:
  buffer_load_dwordx4 a[0:3], v252, s[8:11], s50 offen offset:0
  buffer_load_dwordx4 a[4:7], v252, s[8:11], s50 offen offset:1024
  buffer_load_dwordx4 a[8:11], v252, s[8:11], s50 offen offset:2048
  buffer_load_dwordx4 a[12:15], v252, s[8:11], s50 offen offset:3072
  s_add_u32 s50, s50, 4096
  buffer_load_dwordx4 a[16:19], v252, s[8:11], s50 offen offset:0
  buffer_load_dwordx4 a[20:23], v252, s[8:11], s50 offen offset:1024
  buffer_load_dwordx4 a[24:27], v252, s[8:11], s50 offen offset:2048
  buffer_load_dwordx4 a[28:31], v252, s[8:11], s50 offen offset:3072
  s_add_u32 s50, s50, 4096
  buffer_load_dwordx4 a[32:35], v252, s[8:11], s50 offen offset:0
  buffer_load_dwordx4 a[36:39], v252, s[8:11], s50 offen offset:1024
  buffer_load_dwordx4 a[40:43], v252, s[8:11], s50 offen offset:2048
  buffer_load_dwordx4 a[44:47], v252, s[8:11], s50 offen offset:3072
  s_add_u32 s50, s50, 4096
  buffer_load_dwordx4 a[48:51], v252, s[8:11], s50 offen offset:0
  buffer_load_dwordx4 a[52:55], v252, s[8:11], s50 offen offset:1024
Lk2_p3:
  s_lshl_b32 s20, s56, 3
  s_lshl_b32 s26, s54, 7
  s_add_u32 s26, s26, 25165824
  v_and_b32 v246, 31, v0
  v_lshlrev_b32 v246, 2, v246
  buffer_load_dword v247, v246, s[8:11], s26 offen sc1
  v_and_b32 v3, 15, v0
  v_lshrrev_b32 v4, 4, v0
  v_lshrrev_b32 v5, 2, v3
  v_and_b32 v6, 3, v3
  s_add_u32 s28, s23, 0
  s_lshl_b32 s28, s28, 6
  v_add_u32 v120, s28, v0
  v_lshrrev_b32 v121, 1, v120
  v_and_b32 v122, 1, v120
  v_mul_u32_u24 v123, 8448, v121
  v_lshl_add_u32 v123, v122, 4, v123
  v_cmp_gt_u32 vcc, 448, v120
  v_mov_b32 v124, 2146435072
  s_nop 0
  v_cndmask_b32 v8, v124, v123, vcc
  v_add_u32 v121, 1, v121
  v_cndmask_b32 v121, 0, v121, vcc
  v_lshlrev_b32 v121, 3, v121
  v_lshl_add_u32 v10, v122, 12, v121
  v_add_u32 v10, 17408, v10
  s_add_u32 s28, s23, 4
  buffer_load_dwordx4 a[56:59], v252, s[8:11], s50 offen offset:2048
  s_lshl_b32 s28, s28, 6
  v_add_u32 v120, s28, v0
  v_lshrrev_b32 v121, 1, v120
  v_and_b32 v122, 1, v120
  v_mul_u32_u24 v123, 8448, v121
  v_lshl_add_u32 v123, v122, 4, v123
  v_cmp_gt_u32 vcc, 448, v120
  v_mov_b32 v124, 2146435072
  s_nop 0
  v_cndmask_b32 v9, v124, v123, vcc
  v_add_u32 v121, 1, v121
  v_cndmask_b32 v121, 0, v121, vcc
  v_lshlrev_b32 v121, 3, v121
  v_lshl_add_u32 v11, v122, 12, v121
  v_add_u32 v11, 17408, v11
  s_lshl_b32 s24, s20, 2
  s_add_u32 s24, s24, 4194304
  s_lshl_b32 s26, s23, 4
  v_add_u32 v52, s26, v3
  v_cvt_f32_u32 v52, v52
  v_mul_f32 v128, 0x3c800000, v52
  v_cvt_f32_u32 v53, v4
  v_mul_f32 v129, 0x41000000, v53
  v_mul_f32 v129, v129, v128
  v_and_b32 v131, 1, v3
  v_mul_u32_u24 v131, 0x8000, v131
  v_lshl_or_b32 v131, v131, 16, v131
  v_mov_b32 v140, v129
  buffer_load_dwordx4 a[60:63], v252, s[8:11], s50 offen offset:3072
  v_add_f32 v141, v129, v128
  v_add_f32 v150, v128, v128
  v_cos_f32 v154, v140
  v_cos_f32 v155, v141
  v_sin_f32 v156, v140
  v_sin_f32 v157, v141
  v_cos_f32 v142, v150
  v_sin_f32 v144, v150
  s_nop 0
  v_pk_mul_f32 v[150:151], v[156:157], v[144:145] op_sel_hi:[1,0]
  v_pk_mul_f32 v[152:153], v[154:155], v[144:145] op_sel_hi:[1,0]
  v_pk_fma_f32 v[158:159], v[154:155], v[142:143], v[150:151] op_sel_hi:[1,0,1] neg_lo:[0,0,1] neg_hi:[0,0,1]
  v_pk_fma_f32 v[160:161], v[156:157], v[142:143], v[152:153] op_sel_hi:[1,0,1]
  v_pk_mul_f32 v[150:151], v[160:161], v[144:145] op_sel_hi:[1,0]
  v_pk_mul_f32 v[152:153], v[158:159], v[144:145] op_sel_hi:[1,0]
  v_pk_fma_f32 v[162:163], v[158:159], v[142:143], v[150:151] op_sel_hi:[1,0,1] neg_lo:[0,0,1] neg_hi:[0,0,1]
  v_pk_fma_f32 v[164:165], v[160:161], v[142:143], v[152:153] op_sel_hi:[1,0,1]
  v_pk_mul_f32 v[150:151], v[164:165], v[144:145] op_sel_hi:[1,0]
  v_pk_mul_f32 v[152:153], v[162:163], v[144:145] op_sel_hi:[1,0]
  v_pk_fma_f32 v[166:167], v[162:163], v[142:143], v[150:151] op_sel_hi:[1,0,1] neg_lo:[0,0,1] neg_hi:[0,0,1]
  v_pk_fma_f32 v[168:169], v[164:165], v[142:143], v[152:153] op_sel_hi:[1,0,1]
  v_cvt_pk_bf16_f32 v28, v154, v155
  v_cvt_pk_bf16_f32 v36, v156, v157
  s_add_u32 s50, s50, 4096
  buffer_load_dwordx4 a[64:67], v252, s[8:11], s50 offen offset:0
  v_xor_b32 v44, 0x80008000, v36
  v_xor_b32 v32, v131, v28
  v_xor_b32 v40, v131, v36
  v_xor_b32 v48, 0x80008000, v32
  v_cvt_pk_bf16_f32 v29, v158, v159
  v_cvt_pk_bf16_f32 v37, v160, v161
  v_xor_b32 v45, 0x80008000, v37
  v_xor_b32 v33, v131, v29
  v_xor_b32 v41, v131, v37
  v_xor_b32 v49, 0x80008000, v33
  v_cvt_pk_bf16_f32 v30, v162, v163
  v_cvt_pk_bf16_f32 v38, v164, v165
  v_xor_b32 v46, 0x80008000, v38
  v_xor_b32 v34, v131, v30
  v_xor_b32 v42, v131, v38
  v_xor_b32 v50, 0x80008000, v34
  v_cvt_pk_bf16_f32 v31, v166, v167
  v_cvt_pk_bf16_f32 v39, v168, v169
  v_xor_b32 v47, 0x80008000, v39
  v_xor_b32 v35, v131, v31
  v_xor_b32 v43, v131, v39
  v_xor_b32 v51, 0x80008000, v35
  v_cvt_f32_u32 v54, v5
  v_mul_f32 v128, 0x3b124925, v54
  v_cvt_f32_u32 v130, s26
  v_fmac_f32 v130, 4.0, v53
  v_mul_f32 v129, v130, v128
  buffer_load_dwordx4 a[68:71], v252, s[8:11], s50 offen offset:1024
  v_add_f32 v141, v129, v128
  v_add_f32 v140, v128, v128
  v_cos_f32 v56, v129
  v_cos_f32 v57, v141
  v_sin_f32 v60, v129
  v_sin_f32 v61, v141
  v_cos_f32 v142, v140
  v_sin_f32 v144, v140
  s_nop 0
  v_pk_mul_f32 v[146:147], v[60:61], v[144:145] op_sel_hi:[1,0]
  v_pk_mul_f32 v[148:149], v[56:57], v[144:145] op_sel_hi:[1,0]
  v_pk_fma_f32 v[58:59], v[56:57], v[142:143], v[146:147] op_sel_hi:[1,0,1] neg_lo:[0,0,1] neg_hi:[0,0,1]
  v_pk_fma_f32 v[62:63], v[60:61], v[142:143], v[148:149] op_sel_hi:[1,0,1]
  v_subrev_u32 v120, 0, v5
  v_and_b32 v120, 3, v120
  v_mul_u32_u24 v120, v120, v5
  v_cvt_f32_u32 v120, v120
  v_mul_f32 v120, 0x3e124925, v120
  v_cos_f32 v64, v120
  v_sin_f32 v68, v120
  buffer_load_dwordx4 a[72:75], v252, s[8:11], s50 offen offset:2048
  v_subrev_u32 v120, 1, v5
  v_and_b32 v120, 3, v120
  v_mul_u32_u24 v120, v120, v5
  v_cvt_f32_u32 v120, v120
  v_mul_f32 v120, 0x3e124925, v120
  v_cos_f32 v65, v120
  v_sin_f32 v69, v120
  v_subrev_u32 v120, 2, v5
  v_and_b32 v120, 3, v120
  v_mul_u32_u24 v120, v120, v5
  v_cvt_f32_u32 v120, v120
  v_mul_f32 v120, 0x3e124925, v120
  v_cos_f32 v66, v120
  v_sin_f32 v70, v120
  v_subrev_u32 v120, 3, v5
  v_and_b32 v120, 3, v120
  v_mul_u32_u24 v120, v120, v5
  v_cvt_f32_u32 v120, v120
  v_mul_f32 v120, 0x3e124925, v120
  v_cos_f32 v67, v120
  v_sin_f32 v71, v120
  v_lshl_add_u32 v120, v4, 3, v5
  buffer_load_dwordx4 a[76:79], v252, s[8:11], s50 offen offset:3072
  v_add_u32 v120, 0, v120
  v_mul_u32_u24 v121, 7, v120
  v_add_u32 v121, v121, v6
  v_lshlrev_b32 v72, 3, v121
  v_add_u32 v72, 17408, v72
  v_lshl_add_u32 v120, v4, 3, v5
  v_add_u32 v120, 4, v120
  v_mul_u32_u24 v121, 7, v120
  v_add_u32 v121, v121, v6
  v_lshlrev_b32 v73, 3, v121
  v_add_u32 v73, 17408, v73
  v_lshl_add_u32 v120, v4, 3, v5
  v_add_u32 v120, 32, v120
  v_mul_u32_u24 v121, 7, v120
  v_add_u32 v121, v121, v6
  v_sub_u32 v121, 448, v121
  v_cmp_lt_u32 vcc, 32, v120
  v_cmp_eq_u32 s[28:29], 0, v6
  s_nop 3
  s_and_b64 vcc, vcc, s[28:29]
  v_cndmask_b32 v121, v121, 0, vcc
  v_lshlrev_b32 v74, 3, v121
  v_add_u32 v74, 17408, v74
  v_lshl_add_u32 v120, v4, 3, v5
  v_add_u32 v120, 36, v120
  v_mul_u32_u24 v121, 7, v120
  v_add_u32 v121, v121, v6
  v_sub_u32 v121, 448, v121
  v_cmp_lt_u32 vcc, 32, v120
  v_cmp_eq_u32 s[28:29], 0, v6
  s_nop 3
  s_and_b64 vcc, vcc, s[28:29]
  v_cndmask_b32 v121, v121, 0, vcc
  v_lshlrev_b32 v75, 3, v121
  v_add_u32 v75, 17408, v75
  v_lshrrev_b32 v120, 1, v4
  v_and_b32 v121, 1, v4
  s_lshl_b32 s28, s23, 1
  v_add_u32 v122, s28, v120
  v_mul_u32_u24 v123, 68, v6
  v_add_u32 v122, v122, v123
  v_mul_u32_u24 v123, 9, v5
  v_add_u32 v12, v122, v123
  v_sub_u32 v124, 63, v123
  v_add_u32 v13, v122, v124
  v_cmp_eq_u32 vcc, 0, v5
  v_mov_b32 v124, 64
  v_mul_u32_u24 v125, 68, v6
  v_add_u32 v124, v124, v125
  v_cndmask_b32 v13, v13, v124, vcc
  v_lshlrev_b32 v12, 4, v12
  v_lshl_add_u32 v12, v121, 3, v12
  v_lshlrev_b32 v13, 4, v13
  v_lshl_add_u32 v13, v121, 3, v13
  s_lshl_b32 s28, s23, 6
  v_add_u32 v122, s28, v0
  v_add_u32 v123, 0, v122
  v_mul_u32_u24 v124, 1171, v123
  v_lshrrev_b32 v124, 16, v124
  v_mul_u32_u24 v125, 56, v124
  v_sub_u32 v125, v123, v125
  v_lshrrev_b32 v126, 3, v125
  v_add_u32 v125, v125, v126
  v_mul_u32_u24 v124, 68, v124
  v_add_u32 v124, v124, v125
  v_lshlrev_b32 v14, 4, v124
  v_lshlrev_b32 v244, 4, v123
  v_add_u32 v123, 256, v122
  v_mul_u32_u24 v124, 1171, v123
  v_lshrrev_b32 v124, 16, v124
  v_mul_u32_u24 v125, 56, v124
  v_sub_u32 v125, v123, v125
  v_lshrrev_b32 v126, 3, v125
  v_add_u32 v125, v125, v126
  v_mul_u32_u24 v124, 68, v124
  v_add_u32 v124, v124, v125
  v_lshlrev_b32 v15, 4, v124
  v_lshlrev_b32 v245, 4, v123
  v_cmp_gt_u32 vcc, 192, v122
  v_mov_b32 v123, 2146435072
  s_nop 0
  v_cndmask_b32 v245, v123, v245, vcc
  v_cndmask_b32 v15, 0, v15, vcc
  s_lshl_b32 s28, s23, 1
  v_add_u32 v123, s28, v120
  v_lshl_add_u32 v123, v123, 3, v6
  v_mov_b32 v124, v5
  v_lshl_add_u32 v125, v124, 6, v123
  v_and_b32 v126, 1, v124
  v_lshlrev_b32 v126, 2, v126
  v_xor_b32 v125, v125, v126
  v_lshlrev_b32 v16, 4, v125
  v_lshl_add_u32 v16, v121, 3, v16
  v_xor_b32 v18, 64, v16
  v_sub_u32 v124, 7, v5
  v_lshl_add_u32 v125, v124, 6, v123
  v_and_b32 v126, 1, v124
  v_lshlrev_b32 v126, 2, v126
  v_xor_b32 v125, v125, v126
  v_cmp_eq_u32 vcc, 0, v5
  v_add_u32 v126, 448, v6
  s_nop 0
  v_cndmask_b32 v125, v125, v126, vcc
  v_lshlrev_b32 v17, 4, v125
  v_lshl_add_u32 v17, v121, 3, v17
  v_xor_b32 v19, 64, v17
  v_add_u32 v123, 0, v122
  v_lshrrev_b32 v124, 6, v123
  v_and_b32 v124, 1, v124
  v_lshlrev_b32 v124, 2, v124
  v_xor_b32 v124, v124, v123
  v_lshlrev_b32 v20, 4, v124
  v_lshrrev_b32 v124, 3, v123
  v_and_b32 v125, 7, v123
  v_lshlrev_b32 v125, 4, v125
  v_lshl_add_u32 v22, v124, 9, v125
  v_add_u32 v123, 256, v122
  v_lshrrev_b32 v124, 6, v123
  v_and_b32 v124, 1, v124
  v_lshlrev_b32 v124, 2, v124
  v_xor_b32 v124, v124, v123
  v_lshlrev_b32 v21, 4, v124
  v_lshrrev_b32 v124, 3, v123
  v_and_b32 v125, 7, v123
  v_lshlrev_b32 v125, 4, v125
  v_lshl_add_u32 v23, v124, 9, v125
  v_cmp_gt_u32 vcc, 192, v122
  v_mov_b32 v123, 2146435072
  s_nop 0
  v_cndmask_b32 v23, v123, v23, vcc
  v_cndmask_b32 v21, 0, v21, vcc
  buffer_load_dwordx4 v[112:115], v8, s[8:11], s24 offen sc1
  buffer_load_dwordx4 v[116:119], v9, s[8:11], s24 offen sc1
  s_mov_b32 s28, 0
  s_waitcnt vmcnt(0)
Lp3_chk:
  v_cmp_eq_u32 vcc, -1, v112
  v_cmp_eq_u32 s[30:31], -1, v113
  s_nop 3
  s_or_b64 vcc, vcc, s[30:31]
  v_cmp_eq_u32 s[30:31], -1, v114
  s_nop 3
  s_or_b64 vcc, vcc, s[30:31]
  v_cmp_eq_u32 s[30:31], -1, v115
  s_nop 3
  s_or_b64 vcc, vcc, s[30:31]
  v_cmp_eq_u32 s[30:31], -1, v116
  s_nop 3
  s_or_b64 vcc, vcc, s[30:31]
  v_cmp_eq_u32 s[30:31], -1, v117
  s_nop 3
  s_or_b64 vcc, vcc, s[30:31]
  v_cmp_eq_u32 s[30:31], -1, v118
  s_nop 3
  s_or_b64 vcc, vcc, s[30:31]
  v_cmp_eq_u32 s[30:31], -1, v119
  s_nop 3
  s_or_b64 vcc, vcc, s[30:31]
  s_add_u32 s28, s28, 1
  s_cmp_ge_u32 s28, 6000
  s_cbranch_scc1 Lp3_chkdone
  s_cbranch_vccz Lp3_chkdone
  buffer_load_dwordx4 v[112:115], v8, s[8:11], s24 offen sc1
  buffer_load_dwordx4 v[116:119], v9, s[8:11], s24 offen sc1
  s_waitcnt vmcnt(0)
  s_branch Lp3_chk
Lp3_chkdone:
  v_cmp_ne_u32 vcc, s58, v247
  s_nop 4
  s_cmp_eq_u64 vcc, 0
  s_cselect_b32 s57, 1, 0
  ds_write_b64 v10, v[112:113]
  ds_write_b64 v10, v[114:115] offset:2048
  ds_write_b64 v11, v[116:117]
  ds_write_b64 v11, v[118:119] offset:2048
  s_waitcnt lgkmcnt(0)
  s_barrier
  s_add_u32 s50, s50, 4096
  buffer_load_dwordx4 a[80:83], v252, s[8:11], s50 offen offset:0
  ds_read_b64_tr_b16 v[76:77], v72 offset:0
  ds_read_b64_tr_b16 v[78:79], v73 offset:0
  ds_read_b64_tr_b16 v[80:81], v74 offset:0
  ds_read_b64_tr_b16 v[82:83], v75 offset:0
  ds_read_b64_tr_b16 v[84:85], v72 offset:2048
  ds_read_b64_tr_b16 v[86:87], v73 offset:2048
  ds_read_b64_tr_b16 v[88:89], v74 offset:2048
  buffer_load_dwordx4 a[84:87], v252, s[8:11], s50 offen offset:1024
  ds_read_b64_tr_b16 v[90:91], v75 offset:2048
  ds_read_b64_tr_b16 v[92:93], v72 offset:4096
  ds_read_b64_tr_b16 v[94:95], v73 offset:4096
  ds_read_b64_tr_b16 v[96:97], v74 offset:4096
  ds_read_b64_tr_b16 v[98:99], v75 offset:4096
  ds_read_b64_tr_b16 v[100:101], v72 offset:6144
  ds_read_b64_tr_b16 v[102:103], v73 offset:6144
  ds_read_b64_tr_b16 v[104:105], v74 offset:6144
  ds_read_b64_tr_b16 v[106:107], v75 offset:6144
  s_waitcnt lgkmcnt(14)
  v_mfma_f32_16x16x32_bf16 v[132:135], v[28:31], v[76:79], 0
  buffer_load_dwordx4 a[88:91], v252, s[8:11], s50 offen offset:2048
  v_mfma_f32_16x16x32_bf16 v[136:139], v[36:39], v[76:79], 0
  s_waitcnt lgkmcnt(12)
  v_mfma_f32_16x16x32_bf16 v[132:135], v[32:35], v[80:83], v[132:135]
  v_mfma_f32_16x16x32_bf16 v[136:139], v[40:43], v[80:83], v[136:139]
  s_waitcnt lgkmcnt(10)
  v_mfma_f32_16x16x32_bf16 v[132:135], v[44:47], v[84:87], v[132:135]
  v_mfma_f32_16x16x32_bf16 v[136:139], v[28:31], v[84:87], v[136:139]
  s_waitcnt lgkmcnt(8)
  v_mfma_f32_16x16x32_bf16 v[132:135], v[40:43], v[88:91], v[132:135]
  v_mfma_f32_16x16x32_bf16 v[136:139], v[48:51], v[88:91], v[136:139]
  s_waitcnt lgkmcnt(6)
  v_mfma_f32_16x16x32_bf16 v[140:143], v[28:31], v[92:95], 0
  v_mfma_f32_16x16x32_bf16 v[144:147], v[36:39], v[92:95], 0
  s_waitcnt lgkmcnt(4)
  v_mfma_f32_16x16x32_bf16 v[140:143], v[32:35], v[96:99], v[140:143]
  buffer_load_dwordx4 a[92:95], v252, s[8:11], s50 offen offset:3072
  v_mfma_f32_16x16x32_bf16 v[144:147], v[40:43], v[96:99], v[144:147]
  s_waitcnt lgkmcnt(2)
  v_mfma_f32_16x16x32_bf16 v[140:143], v[44:47], v[100:103], v[140:143]
  v_mfma_f32_16x16x32_bf16 v[144:147], v[28:31], v[100:103], v[144:147]
  s_waitcnt lgkmcnt(0)
  v_mfma_f32_16x16x32_bf16 v[140:143], v[40:43], v[104:107], v[140:143]
  v_mfma_f32_16x16x32_bf16 v[144:147], v[48:51], v[104:107], v[144:147]
  v_lshlrev_b32 v172, 16, v228
  v_and_b32 v173, 0xffff0000, v228
  v_lshlrev_b32 v174, 16, v229
  v_and_b32 v175, 0xffff0000, v229
  v_lshlrev_b32 v176, 16, v230
  v_and_b32 v177, 0xffff0000, v230
  v_lshlrev_b32 v178, 16, v231
  v_and_b32 v179, 0xffff0000, v231
  v_lshlrev_b32 v180, 16, v232
  v_and_b32 v181, 0xffff0000, v232
  v_lshlrev_b32 v182, 16, v233
  v_and_b32 v183, 0xffff0000, v233
  v_lshlrev_b32 v184, 16, v234
  v_and_b32 v185, 0xffff0000, v234
  v_lshlrev_b32 v186, 16, v235
  v_and_b32 v187, 0xffff0000, v235
  v_pk_mul_f32 v[124:125], v[136:137], v[60:61]
  v_pk_mul_f32 v[126:127], v[132:133], v[60:61]
  v_pk_fma_f32 v[132:133], v[132:133], v[56:57], v[124:125] neg_lo:[0,0,1] neg_hi:[0,0,1]
  s_add_u32 s50, s50, 4096
  buffer_load_dwordx4 a[96:99], v252, s[8:11], s50 offen offset:0
  v_pk_fma_f32 v[136:137], v[136:137], v[56:57], v[126:127]
  v_pk_mul_f32 v[124:125], v[138:139], v[62:63]
  v_pk_mul_f32 v[126:127], v[134:135], v[62:63]
  v_pk_fma_f32 v[134:135], v[134:135], v[58:59], v[124:125] neg_lo:[0,0,1] neg_hi:[0,0,1]
  v_pk_fma_f32 v[138:139], v[138:139], v[58:59], v[126:127]
  v_pk_mul_f32 v[124:125], v[144:145], v[60:61]
  v_pk_mul_f32 v[126:127], v[140:141], v[60:61]
  v_pk_fma_f32 v[140:141], v[140:141], v[56:57], v[124:125] neg_lo:[0,0,1] neg_hi:[0,0,1]
  v_pk_fma_f32 v[144:145], v[144:145], v[56:57], v[126:127]
  v_pk_mul_f32 v[124:125], v[146:147], v[62:63]
  v_pk_mul_f32 v[126:127], v[142:143], v[62:63]
  v_pk_fma_f32 v[142:143], v[142:143], v[58:59], v[124:125] neg_lo:[0,0,1] neg_hi:[0,0,1]
  v_pk_fma_f32 v[146:147], v[146:147], v[58:59], v[126:127]
  v_mul_f32 v108, v132, v64
  v_mul_f32 v112, v136, v68
  v_mul_f32 v109, v133, v64
  v_mul_f32 v113, v137, v68
  v_mul_f32 v110, v134, v64
  v_mul_f32 v114, v138, v68
  v_mul_f32 v111, v135, v64
  v_mul_f32 v115, v139, v68
  v_fmac_f32_dpp v108, v132, v65 row_ror:4 row_mask:0xf bank_mask:0xf
  v_fmac_f32_dpp v112, v136, v69 row_ror:4 row_mask:0xf bank_mask:0xf
  v_fmac_f32_dpp v109, v133, v65 row_ror:4 row_mask:0xf bank_mask:0xf
  v_fmac_f32_dpp v113, v137, v69 row_ror:4 row_mask:0xf bank_mask:0xf
  v_fmac_f32_dpp v110, v134, v65 row_ror:4 row_mask:0xf bank_mask:0xf
  v_fmac_f32_dpp v114, v138, v69 row_ror:4 row_mask:0xf bank_mask:0xf
  v_fmac_f32_dpp v111, v135, v65 row_ror:4 row_mask:0xf bank_mask:0xf
  v_fmac_f32_dpp v115, v139, v69 row_ror:4 row_mask:0xf bank_mask:0xf
  v_fmac_f32_dpp v108, v132, v66 row_ror:8 row_mask:0xf bank_mask:0xf
  v_fmac_f32_dpp v112, v136, v70 row_ror:8 row_mask:0xf bank_mask:0xf
  v_fmac_f32_dpp v109, v133, v66 row_ror:8 row_mask:0xf bank_mask:0xf
  v_fmac_f32_dpp v113, v137, v70 row_ror:8 row_mask:0xf bank_mask:0xf
  v_fmac_f32_dpp v110, v134, v66 row_ror:8 row_mask:0xf bank_mask:0xf
  v_fmac_f32_dpp v114, v138, v70 row_ror:8 row_mask:0xf bank_mask:0xf
  v_fmac_f32_dpp v111, v135, v66 row_ror:8 row_mask:0xf bank_mask:0xf
  v_fmac_f32_dpp v115, v139, v70 row_ror:8 row_mask:0xf bank_mask:0xf
  v_fmac_f32_dpp v108, v132, v67 row_ror:12 row_mask:0xf bank_mask:0xf
  v_fmac_f32_dpp v112, v136, v71 row_ror:12 row_mask:0xf bank_mask:0xf
  v_fmac_f32_dpp v109, v133, v67 row_ror:12 row_mask:0xf bank_mask:0xf
  v_fmac_f32_dpp v113, v137, v71 row_ror:12 row_mask:0xf bank_mask:0xf
  buffer_load_dwordx4 a[100:103], v252, s[8:11], s50 offen offset:1024
  v_fmac_f32_dpp v110, v134, v67 row_ror:12 row_mask:0xf bank_mask:0xf
  v_fmac_f32_dpp v114, v138, v71 row_ror:12 row_mask:0xf bank_mask:0xf
  v_fmac_f32_dpp v111, v135, v67 row_ror:12 row_mask:0xf bank_mask:0xf
  v_fmac_f32_dpp v115, v139, v71 row_ror:12 row_mask:0xf bank_mask:0xf
  v_pk_add_f32 v[148:149], v[108:109], v[112:113] neg_lo:[0,1] neg_hi:[0,1]
  v_pk_add_f32 v[152:153], v[108:109], v[112:113]
  v_pk_add_f32 v[150:151], v[110:111], v[114:115] neg_lo:[0,1] neg_hi:[0,1]
  v_pk_add_f32 v[154:155], v[110:111], v[114:115]
  v_pk_add_f32 v[148:149], v[148:149], v[172:173]
  v_pk_fma_f32 v[152:153], v[152:153], v[238:239], v[176:177] op_sel_hi:[1,0,1]
  v_pk_add_f32 v[150:151], v[150:151], v[174:175]
  v_pk_fma_f32 v[154:155], v[154:155], v[238:239], v[178:179] op_sel_hi:[1,0,1]
  v_cvt_pk_bf16_f32 v164, v148, v149
  v_cvt_pk_bf16_f32 v165, v150, v151
  v_lshlrev_b32 v172, 16, v164
  v_and_b32 v173, 0xffff0000, v164
  v_lshlrev_b32 v174, 16, v165
  v_and_b32 v175, 0xffff0000, v165
  v_cvt_pk_bf16_f32 v166, v152, v153
  v_cvt_pk_bf16_f32 v167, v154, v155
  v_lshlrev_b32 v176, 16, v166
  v_and_b32 v177, 0xffff0000, v166
  v_lshlrev_b32 v178, 16, v167
  v_and_b32 v179, 0xffff0000, v167
  v_mul_f32 v196, v140, v64
  v_mul_f32 v200, v144, v68
  v_mul_f32 v197, v141, v64
  v_mul_f32 v201, v145, v68
  v_mul_f32 v198, v142, v64
  v_mul_f32 v202, v146, v68
  v_mul_f32 v199, v143, v64
  v_mul_f32 v203, v147, v68
  v_fmac_f32_dpp v196, v140, v65 row_ror:4 row_mask:0xf bank_mask:0xf
  v_fmac_f32_dpp v200, v144, v69 row_ror:4 row_mask:0xf bank_mask:0xf
  v_fmac_f32_dpp v197, v141, v65 row_ror:4 row_mask:0xf bank_mask:0xf
  v_fmac_f32_dpp v201, v145, v69 row_ror:4 row_mask:0xf bank_mask:0xf
  v_fmac_f32_dpp v198, v142, v65 row_ror:4 row_mask:0xf bank_mask:0xf
  v_fmac_f32_dpp v202, v146, v69 row_ror:4 row_mask:0xf bank_mask:0xf
  v_fmac_f32_dpp v199, v143, v65 row_ror:4 row_mask:0xf bank_mask:0xf
  v_fmac_f32_dpp v203, v147, v69 row_ror:4 row_mask:0xf bank_mask:0xf
  buffer_load_dwordx4 a[104:107], v252, s[8:11], s50 offen offset:2048
  v_fmac_f32_dpp v196, v140, v66 row_ror:8 row_mask:0xf bank_mask:0xf
  v_fmac_f32_dpp v200, v144, v70 row_ror:8 row_mask:0xf bank_mask:0xf
  v_fmac_f32_dpp v197, v141, v66 row_ror:8 row_mask:0xf bank_mask:0xf
  v_fmac_f32_dpp v201, v145, v70 row_ror:8 row_mask:0xf bank_mask:0xf
  v_fmac_f32_dpp v198, v142, v66 row_ror:8 row_mask:0xf bank_mask:0xf
  v_fmac_f32_dpp v202, v146, v70 row_ror:8 row_mask:0xf bank_mask:0xf
  v_fmac_f32_dpp v199, v143, v66 row_ror:8 row_mask:0xf bank_mask:0xf
  v_fmac_f32_dpp v203, v147, v70 row_ror:8 row_mask:0xf bank_mask:0xf
  v_fmac_f32_dpp v196, v140, v67 row_ror:12 row_mask:0xf bank_mask:0xf
  v_fmac_f32_dpp v200, v144, v71 row_ror:12 row_mask:0xf bank_mask:0xf
  v_fmac_f32_dpp v197, v141, v67 row_ror:12 row_mask:0xf bank_mask:0xf
  v_fmac_f32_dpp v201, v145, v71 row_ror:12 row_mask:0xf bank_mask:0xf
  v_fmac_f32_dpp v198, v142, v67 row_ror:12 row_mask:0xf bank_mask:0xf
  v_fmac_f32_dpp v202, v146, v71 row_ror:12 row_mask:0xf bank_mask:0xf
  v_fmac_f32_dpp v199, v143, v67 row_ror:12 row_mask:0xf bank_mask:0xf
  v_fmac_f32_dpp v203, v147, v71 row_ror:12 row_mask:0xf bank_mask:0xf
  v_pk_add_f32 v[156:157], v[196:197], v[200:201] neg_lo:[0,1] neg_hi:[0,1]
  v_pk_add_f32 v[160:161], v[196:197], v[200:201]
  v_pk_add_f32 v[158:159], v[198:199], v[202:203] neg_lo:[0,1] neg_hi:[0,1]
  v_pk_add_f32 v[162:163], v[198:199], v[202:203]
  v_pk_add_f32 v[156:157], v[156:157], v[180:181]
  v_pk_fma_f32 v[160:161], v[160:161], v[238:239], v[184:185] op_sel_hi:[1,0,1]
  v_pk_add_f32 v[158:159], v[158:159], v[182:183]
  v_pk_fma_f32 v[162:163], v[162:163], v[238:239], v[186:187] op_sel_hi:[1,0,1]
  v_cvt_pk_bf16_f32 v168, v156, v157
  v_cvt_pk_bf16_f32 v169, v158, v159
  v_lshlrev_b32 v180, 16, v168
  v_and_b32 v181, 0xffff0000, v168
  v_lshlrev_b32 v182, 16, v169
  v_and_b32 v183, 0xffff0000, v169
  v_cvt_pk_bf16_f32 v170, v160, v161
  v_cvt_pk_bf16_f32 v171, v162, v163
  v_lshlrev_b32 v184, 16, v170
  v_and_b32 v185, 0xffff0000, v170
  v_lshlrev_b32 v186, 16, v171
  v_and_b32 v187, 0xffff0000, v171
  ds_write_b64 v12, v[164:165] offset:27648
  buffer_load_dwordx4 a[108:111], v252, s[8:11], s50 offen offset:3072
  ds_write_b64 v13, v[166:167] offset:27648
  ds_write_b64 v12, v[168:169] offset:32000
  ds_write_b64 v13, v[170:171] offset:32000
  v_pk_add_f32 v[188:189], v[172:173], v[174:175]
  v_pk_mul_f32 v[190:191], v[172:173], v[172:173]
  v_pk_add_f32 v[188:189], v[188:189], v[176:177]
  v_pk_fma_f32 v[190:191], v[174:175], v[174:175], v[190:191]
  v_pk_add_f32 v[188:189], v[188:189], v[178:179]
  v_pk_fma_f32 v[190:191], v[176:177], v[176:177], v[190:191]
  v_pk_fma_f32 v[190:191], v[178:179], v[178:179], v[190:191]
  v_pk_add_f32 v[192:193], v[180:181], v[182:183]
  v_pk_mul_f32 v[194:195], v[180:181], v[180:181]
  v_pk_add_f32 v[192:193], v[192:193], v[184:185]
  v_pk_fma_f32 v[194:195], v[182:183], v[182:183], v[194:195]
  v_pk_add_f32 v[192:193], v[192:193], v[186:187]
  v_pk_fma_f32 v[194:195], v[184:185], v[184:185], v[194:195]
  v_pk_fma_f32 v[194:195], v[186:187], v[186:187], v[194:195]
  v_add_f32 v188, v188, v189
  v_add_f32 v189, v190, v191
  v_add_f32 v192, v192, v193
  v_add_f32 v193, v194, v195
  v_add_f32_dpp v188, v188, v188 row_ror:4 row_mask:0xf bank_mask:0xf
  v_add_f32_dpp v189, v189, v189 row_ror:4 row_mask:0xf bank_mask:0xf
  v_add_f32_dpp v192, v192, v192 row_ror:4 row_mask:0xf bank_mask:0xf
  v_add_f32_dpp v193, v193, v193 row_ror:4 row_mask:0xf bank_mask:0xf
  v_add_f32_dpp v188, v188, v188 row_ror:8 row_mask:0xf bank_mask:0xf
  v_add_f32_dpp v189, v189, v189 row_ror:8 row_mask:0xf bank_mask:0xf
  v_add_f32_dpp v192, v192, v192 row_ror:8 row_mask:0xf bank_mask:0xf
  v_add_f32_dpp v193, v193, v193 row_ror:8 row_mask:0xf bank_mask:0xf
  v_lshlrev_b32 v108, 3, v6
  s_lshl_b32 s28, s23, 8
  buffer_load_dwordx4 a[112:115], v252, s[8:11], s51 offen offset:0
  v_lshl_add_u32 v109, v4, 6, v108
  v_add_u32 v109, s28, v109
  s_mov_b32 exec_lo, 0x000f000f
  s_mov_b32 exec_hi, 0x000f000f
  ds_write_b64 v109, v[188:189] offset:25600
  ds_write_b64 v109, v[192:193] offset:25632
  s_mov_b64 exec, -1
  v_lshl_add_u32 v110, v4, 8, v108
  s_waitcnt lgkmcnt(0)
  s_barrier
  buffer_load_dwordx4 a[116:119], v252, s[8:11], s51 offen offset:1024
  s_mul_i32 s27, s20, 896
  s_add_u32 s27, s27, 6291456
  ds_read_b128 v[92:95], v14 offset:27648
  ds_read_b128 v[96:99], v15 offset:27648
  ds_read_b64 v[76:77], v110 offset:25600
  ds_read_b64 v[78:79], v110 offset:25664
  ds_read_b64 v[80:81], v110 offset:25728
  ds_read_b64 v[82:83], v110 offset:25792
  ds_read_b64 v[84:85], v110 offset:25632
  ds_read_b64 v[86:87], v110 offset:25696
  ds_read_b64 v[88:89], v110 offset:25760
  buffer_load_dwordx4 a[120:123], v252, s[8:11], s51 offen offset:2048
  ds_read_b64 v[90:91], v110 offset:25824
  s_waitcnt lgkmcnt(6)
  v_pk_add_f32 v[76:77], v[76:77], v[78:79]
  s_waitcnt lgkmcnt(4)
  v_pk_add_f32 v[80:81], v[80:81], v[82:83]
  v_pk_add_f32 v[76:77], v[76:77], v[80:81]
  s_waitcnt lgkmcnt(2)
  v_pk_add_f32 v[84:85], v[84:85], v[86:87]
  s_waitcnt lgkmcnt(0)
  v_pk_add_f32 v[88:89], v[88:89], v[90:91]
  v_pk_add_f32 v[84:85], v[84:85], v[88:89]
  buffer_store_dwordx4 v[92:95], v244, s[8:11], s27 offen sc1
  buffer_store_dwordx4 v[96:99], v245, s[8:11], s27 offen sc1
  v_mov_b32 v78, v76
  v_mov_b32 v79, v77
  v_mov_b32 v86, v84
  v_mov_b32 v87, v85
  v_permlane16_swap_b32 v76, v78
  v_permlane16_swap_b32 v77, v79
  v_permlane16_swap_b32 v84, v86
  v_permlane16_swap_b32 v85, v87
  v_pk_add_f32 v[76:77], v[76:77], v[78:79]
  v_pk_add_f32 v[84:85], v[84:85], v[86:87]
  v_mov_b32 v78, v76
  v_mov_b32 v79, v77
  v_mov_b32 v86, v84
  v_mov_b32 v87, v85
  v_permlane32_swap_b32 v76, v78
  v_permlane32_swap_b32 v77, v79
  v_permlane32_swap_b32 v84, v86
  v_permlane32_swap_b32 v85, v87
  v_pk_add_f32 v[76:77], v[76:77], v[78:79]
  v_pk_add_f32 v[84:85], v[84:85], v[86:87]
  v_mul_f32 v76, 0x3b124925, v76
  v_mul_f32 v77, 0x3b124925, v77
  v_mul_f32 v84, 0x3b124925, v84
  v_mul_f32 v85, 0x3b124925, v85
  v_fma_f32 v77, -v76, v76, v77
  v_fma_f32 v85, -v84, v84, v85
  v_max_f32 v77, 0, v77
  buffer_load_dwordx4 a[124:127], v252, s[8:11], s51 offen offset:3072
  v_max_f32 v85, 0, v85
  v_add_f32 v77, 0x3727c5ac, v77
  v_add_f32 v85, 0x3727c5ac, v85
  v_rsq_f32 v78, v77
  v_rsq_f32 v86, v85
  v_mul_f32 v80, v76, v78
  v_mul_f32 v88, v84, v86
  v_pk_fma_f32 v[172:173], v[172:173], v[78:79], v[80:81] op_sel_hi:[1,0,0] neg_lo:[0,0,1] neg_hi:[0,0,1]
  v_pk_fma_f32 v[174:175], v[174:175], v[78:79], v[80:81] op_sel_hi:[1,0,0] neg_lo:[0,0,1] neg_hi:[0,0,1]
  v_cvt_pk_bf16_f32 v148, v172, v173
  v_cvt_pk_bf16_f32 v149, v174, v175
  ds_write_b64 v16, v[148:149] offset:36864
  v_pk_fma_f32 v[176:177], v[176:177], v[78:79], v[80:81] op_sel_hi:[1,0,0] neg_lo:[0,0,1] neg_hi:[0,0,1]
  v_pk_fma_f32 v[178:179], v[178:179], v[78:79], v[80:81] op_sel_hi:[1,0,0] neg_lo:[0,0,1] neg_hi:[0,0,1]
  v_cvt_pk_bf16_f32 v150, v176, v177
  v_cvt_pk_bf16_f32 v151, v178, v179
  ds_write_b64 v17, v[150:151] offset:36864
  v_pk_fma_f32 v[180:181], v[180:181], v[86:87], v[88:89] op_sel_hi:[1,0,0] neg_lo:[0,0,1] neg_hi:[0,0,1]
  v_pk_fma_f32 v[182:183], v[182:183], v[86:87], v[88:89] op_sel_hi:[1,0,0] neg_lo:[0,0,1] neg_hi:[0,0,1]
  v_cvt_pk_bf16_f32 v152, v180, v181
  v_cvt_pk_bf16_f32 v153, v182, v183
  ds_write_b64 v18, v[152:153] offset:36864
  v_pk_fma_f32 v[184:185], v[184:185], v[86:87], v[88:89] op_sel_hi:[1,0,0] neg_lo:[0,0,1] neg_hi:[0,0,1]
  v_pk_fma_f32 v[186:187], v[186:187], v[86:87], v[88:89] op_sel_hi:[1,0,0] neg_lo:[0,0,1] neg_hi:[0,0,1]
  v_cvt_pk_bf16_f32 v154, v184, v185
  v_cvt_pk_bf16_f32 v155, v186, v187
  ds_write_b64 v19, v[154:155] offset:36864
  s_lshr_b32 s28, s20, 5
  s_mul_i32 s28, s28, 28672
  s_and_b32 s29, s20, 31
  s_lshl_b32 s29, s29, 4
  s_add_u32 s28, s28, s29
  s_add_u32 s28, s28, 8388608
  s_waitcnt lgkmcnt(0)
  s_barrier
  ds_read_b128 v[92:95], v20 offset:36864
  ds_read_b128 v[96:99], v21 offset:36864
  s_waitcnt lgkmcnt(0)
  s_cmp_eq_u32 s57, 1
  s_cbranch_scc1 Lp3_af_fast
  buffer_store_dwordx4 v[92:95], v22, s[8:11], s28 offen sc1
  buffer_store_dwordx4 v[96:99], v23, s[8:11], s28 offen sc1
  s_branch Lp3_af_done
Lp3_af_fast:
  buffer_store_dwordx4 v[92:95], v22, s[8:11], s28 offen
  buffer_store_dwordx4 v[96:99], v23, s[8:11], s28 offen
Lp3_af_done:
  s_lshr_b32 s59, s55, 4
  s_lshl_b32 s20, s54, 1
  s_add_u32 s20, s20, s59
  s_and_b32 s21, s55, 15
  s_mul_i32 s24, s55, 9363
  s_lshr_b32 s60, s24, 16
  s_mul_i32 s24, s60, 7
  s_sub_u32 s61, s55, s24
  s_mul_i32 s52, s61, 229376
  s_mul_i32 s53, s23, 28672
  s_add_u32 s52, s52, s53
  s_add_u32 s52, s52, 14680064
  s_add_u32 s53, s52, 114688
  s_lshl_b32 s63, s23, 3
  v_add_u32 v14, s63, v0
  v_and_b32 v14, 31, v14
  v_and_b32 v13, 32, v0
  v_or_b32 v14, v14, v13
  v_lshlrev_b32 v14, 4, v14
  s_mov_b32 s36, 0xbfb8aa3b
  s_mov_b32 s38, 1.0
  s_lshl_b32 s32, s20, 2
  s_mul_i32 s32, s32, 28672
  s_add_u32 s32, s32, 8388608
  s_lshl_b32 s40, s20, 2
  s_mul_i32 s40, s40, 114688
  s_mul_i32 s41, s21, 7
  s_lshl_b32 s42, s23, 1
  s_add_u32 s41, s41, s42
  s_lshl_b32 s41, s41, 10
  s_add_u32 s40, s40, s41
  s_add_u32 s40, s40, 16777216
  s_add_u32 s41, s40, 1024
  s_waitcnt vmcnt(0)
  s_barrier
  s_lshr_b32 s64, s60, 1
  s_and_b32 s64, s64, 1
  s_and_b32 s65, s60, 1
  s_lshl_b32 s30, s54, 1
  s_add_u32 s30, s30, s64
  s_lshl_b32 s30, s30, 2
  s_add_u32 s30, s30, s65
  s_mov_b32 s46, s30
  s_mul_i32 s30, s30, 114688
  s_mul_i32 s31, s23, 28672
  s_add_u32 s30, s30, s31
  s_add_u32 s30, s30, 16777216
  s_add_u32 s31, s30, 229376
  s_cmp_eq_u32 s23, 3
  s_cbranch_scc1 Lp4_loader
  s_add_u32 s51, s51, 4096
  buffer_load_dwordx4 a[128:131], v252, s[8:11], s51 offen offset:0
  buffer_load_dwordx4 a[132:135], v252, s[8:11], s51 offen offset:1024
  buffer_load_dwordx4 a[136:139], v252, s[8:11], s51 offen offset:2048
  buffer_load_dwordx4 a[140:143], v252, s[8:11], s51 offen offset:3072
  s_add_u32 s51, s51, 4096
  buffer_load_dwordx4 a[144:147], v252, s[8:11], s51 offen offset:0
  buffer_load_dwordx4 a[148:151], v252, s[8:11], s51 offen offset:1024
  buffer_load_dwordx4 a[152:155], v252, s[8:11], s51 offen offset:2048
  buffer_load_dwordx4 a[156:159], v252, s[8:11], s51 offen offset:3072
  s_add_u32 s51, s51, 4096
  buffer_load_dwordx4 a[160:163], v252, s[8:11], s51 offen offset:0
  buffer_load_dwordx4 a[164:167], v252, s[8:11], s51 offen offset:1024
  s_barrier
  s_barrier
  ds_read_b128 v[80:83], v252 offset:0
  ds_read_b128 v[84:87], v252 offset:1024
  ds_read_b128 v[88:91], v252 offset:2048
  ds_read_b128 v[92:95], v252 offset:3072
  ds_read_b128 v[96:99], v252 offset:4096
  s_waitcnt lgkmcnt(4)
  v_mfma_f32_32x32x16_bf16 v[16:31], a[0:3], v[80:83], 0
  buffer_load_dwordx4 a[168:171], v252, s[8:11], s51 offen offset:2048
  v_mfma_f32_32x32x16_bf16 v[32:47], a[112:115], v[80:83], 0
  ds_read_b128 v[100:103], v252 offset:5120
  s_waitcnt lgkmcnt(4)
  v_mfma_f32_32x32x16_bf16 v[16:31], a[4:7], v[84:87], v[16:31]
  buffer_load_dwordx4 a[172:175], v252, s[8:11], s51 offen offset:3072
  v_mfma_f32_32x32x16_bf16 v[32:47], a[116:119], v[84:87], v[32:47]
  ds_read_b128 v[80:83], v252 offset:6144
  s_waitcnt lgkmcnt(4)
  v_mfma_f32_32x32x16_bf16 v[16:31], a[8:11], v[88:91], v[16:31]
  s_add_u32 s51, s51, 4096
  v_mfma_f32_32x32x16_bf16 v[32:47], a[120:123], v[88:91], v[32:47]
  buffer_load_dwordx4 a[176:179], v252, s[8:11], s51 offen offset:0
  ds_read_b128 v[84:87], v252 offset:7168
  s_waitcnt lgkmcnt(4)
  v_mfma_f32_32x32x16_bf16 v[16:31], a[12:15], v[92:95], v[16:31]
  v_mfma_f32_32x32x16_bf16 v[32:47], a[124:127], v[92:95], v[32:47]
  buffer_load_dwordx4 a[180:183], v252, s[8:11], s51 offen offset:1024
  ds_read_b128 v[88:91], v252 offset:8192
  s_waitcnt lgkmcnt(4)
  v_mfma_f32_32x32x16_bf16 v[16:31], a[16:19], v[96:99], v[16:31]
  s_waitcnt vmcnt(13)
  v_mfma_f32_32x32x16_bf16 v[32:47], a[128:131], v[96:99], v[32:47]
  buffer_load_dwordx4 a[184:187], v252, s[8:11], s51 offen offset:2048
  ds_read_b128 v[92:95], v252 offset:9216
  s_waitcnt lgkmcnt(4)
  v_mfma_f32_32x32x16_bf16 v[16:31], a[20:23], v[100:103], v[16:31]
  s_waitcnt vmcnt(13)
  v_mfma_f32_32x32x16_bf16 v[32:47], a[132:135], v[100:103], v[32:47]
  buffer_load_dwordx4 a[188:191], v252, s[8:11], s51 offen offset:3072
  ds_read_b128 v[96:99], v252 offset:10240
  s_waitcnt lgkmcnt(4)
  v_mfma_f32_32x32x16_bf16 v[16:31], a[24:27], v[80:83], v[16:31]
  s_add_u32 s51, s51, 4096
  s_waitcnt vmcnt(13)
  v_mfma_f32_32x32x16_bf16 v[32:47], a[136:139], v[80:83], v[32:47]
  ds_read_b128 v[100:103], v252 offset:11264
  s_waitcnt lgkmcnt(4)
  v_mfma_f32_32x32x16_bf16 v[16:31], a[28:31], v[84:87], v[16:31]
  buffer_load_dwordx4 a[192:195], v252, s[8:11], s51 offen offset:0
  s_waitcnt vmcnt(13)
  v_mfma_f32_32x32x16_bf16 v[32:47], a[140:143], v[84:87], v[32:47]
  ds_read_b128 v[80:83], v252 offset:12288
  s_waitcnt lgkmcnt(4)
  v_mfma_f32_32x32x16_bf16 v[16:31], a[32:35], v[88:91], v[16:31]
  buffer_load_dwordx4 a[196:199], v252, s[8:11], s51 offen offset:1024
  s_waitcnt vmcnt(13)
  v_mfma_f32_32x32x16_bf16 v[32:47], a[144:147], v[88:91], v[32:47]
  ds_read_b128 v[84:87], v252 offset:13312
  s_waitcnt lgkmcnt(4)
  v_mfma_f32_32x32x16_bf16 v[16:31], a[36:39], v[92:95], v[16:31]
  buffer_load_dwordx4 a[200:203], v252, s[8:11], s51 offen offset:2048
  s_waitcnt vmcnt(13)
  v_mfma_f32_32x32x16_bf16 v[32:47], a[148:151], v[92:95], v[32:47]
  ds_read_b128 v[88:91], v252 offset:14336
  s_waitcnt lgkmcnt(4)
  v_mfma_f32_32x32x16_bf16 v[16:31], a[40:43], v[96:99], v[16:31]
  buffer_load_dwordx4 a[204:207], v252, s[8:11], s51 offen offset:3072
  s_waitcnt vmcnt(13)
  v_mfma_f32_32x32x16_bf16 v[32:47], a[152:155], v[96:99], v[32:47]
  s_add_u32 s51, s51, 4096
  ds_read_b128 v[92:95], v252 offset:15360
  s_waitcnt lgkmcnt(4)
  v_mfma_f32_32x32x16_bf16 v[16:31], a[44:47], v[100:103], v[16:31]
  buffer_load_dwordx4 a[208:211], v252, s[8:11], s51 offen offset:0
  s_waitcnt vmcnt(13)
  v_mfma_f32_32x32x16_bf16 v[32:47], a[156:159], v[100:103], v[32:47]
  ds_read_b128 v[96:99], v252 offset:16384
  s_waitcnt lgkmcnt(4)
  v_mfma_f32_32x32x16_bf16 v[16:31], a[48:51], v[80:83], v[16:31]
  buffer_load_dwordx4 a[212:215], v252, s[8:11], s51 offen offset:1024
  s_waitcnt vmcnt(13)
  v_mfma_f32_32x32x16_bf16 v[32:47], a[160:163], v[80:83], v[32:47]
  ds_read_b128 v[100:103], v252 offset:17408
  s_waitcnt lgkmcnt(4)
  v_mfma_f32_32x32x16_bf16 v[16:31], a[52:55], v[84:87], v[16:31]
  buffer_load_dwordx4 a[216:219], v252, s[8:11], s51 offen offset:2048
  s_waitcnt vmcnt(13)
  v_mfma_f32_32x32x16_bf16 v[32:47], a[164:167], v[84:87], v[32:47]
  ds_read_b128 v[80:83], v252 offset:18432
  s_waitcnt lgkmcnt(4)
  v_mfma_f32_32x32x16_bf16 v[16:31], a[56:59], v[88:91], v[16:31]
  buffer_load_dwordx4 a[220:223], v252, s[8:11], s51 offen offset:3072
  s_waitcnt vmcnt(13)
  v_mfma_f32_32x32x16_bf16 v[32:47], a[168:171], v[88:91], v[32:47]
  ds_read_b128 v[84:87], v252 offset:19456
  s_waitcnt lgkmcnt(4)
  v_mfma_f32_32x32x16_bf16 v[16:31], a[60:63], v[92:95], v[16:31]
  s_waitcnt vmcnt(12)
  v_mfma_f32_32x32x16_bf16 v[32:47], a[172:175], v[92:95], v[32:47]
  ds_read_b128 v[88:91], v252 offset:20480
  s_waitcnt lgkmcnt(4)
  v_mfma_f32_32x32x16_bf16 v[16:31], a[64:67], v[96:99], v[16:31]
  s_waitcnt vmcnt(11)
  v_mfma_f32_32x32x16_bf16 v[32:47], a[176:179], v[96:99], v[32:47]
  s_barrier
  ds_read_b128 v[92:95], v252 offset:21504
  s_waitcnt lgkmcnt(4)
  v_mfma_f32_32x32x16_bf16 v[16:31], a[68:71], v[100:103], v[16:31]
  s_waitcnt vmcnt(10)
  v_mfma_f32_32x32x16_bf16 v[32:47], a[180:183], v[100:103], v[32:47]
  ds_read_b128 v[96:99], v252 offset:22528
  s_waitcnt lgkmcnt(4)
  v_mfma_f32_32x32x16_bf16 v[16:31], a[72:75], v[80:83], v[16:31]
  s_waitcnt vmcnt(9)
  v_mfma_f32_32x32x16_bf16 v[32:47], a[184:187], v[80:83], v[32:47]
  ds_read_b128 v[100:103], v252 offset:23552
  s_waitcnt lgkmcnt(4)
  v_mfma_f32_32x32x16_bf16 v[16:31], a[76:79], v[84:87], v[16:31]
  s_waitcnt vmcnt(8)
  v_mfma_f32_32x32x16_bf16 v[32:47], a[188:191], v[84:87], v[32:47]
  ds_read_b128 v[80:83], v252 offset:24576
  s_waitcnt lgkmcnt(4)
  v_mfma_f32_32x32x16_bf16 v[16:31], a[80:83], v[88:91], v[16:31]
  s_waitcnt vmcnt(7)
  v_mfma_f32_32x32x16_bf16 v[32:47], a[192:195], v[88:91], v[32:47]
  ds_read_b128 v[84:87], v252 offset:25600
  s_waitcnt lgkmcnt(4)
  v_mfma_f32_32x32x16_bf16 v[16:31], a[84:87], v[92:95], v[16:31]
  s_waitcnt vmcnt(6)
  v_mfma_f32_32x32x16_bf16 v[32:47], a[196:199], v[92:95], v[32:47]
  ds_read_b128 v[88:91], v252 offset:26624
  s_waitcnt lgkmcnt(4)
  v_mfma_f32_32x32x16_bf16 v[16:31], a[88:91], v[96:99], v[16:31]
  s_waitcnt vmcnt(5)
  v_mfma_f32_32x32x16_bf16 v[32:47], a[200:203], v[96:99], v[32:47]
  ds_read_b128 v[92:95], v252 offset:27648
  s_waitcnt lgkmcnt(4)
  v_mfma_f32_32x32x16_bf16 v[16:31], a[92:95], v[100:103], v[16:31]
  s_waitcnt vmcnt(4)
  v_mfma_f32_32x32x16_bf16 v[32:47], a[204:207], v[100:103], v[32:47]
  ds_read_b128 v[96:99], v252 offset:28672
  s_waitcnt lgkmcnt(4)
  v_mfma_f32_32x32x16_bf16 v[16:31], a[96:99], v[80:83], v[16:31]
  s_waitcnt vmcnt(3)
  v_mfma_f32_32x32x16_bf16 v[32:47], a[208:211], v[80:83], v[32:47]
  ds_read_b128 v[100:103], v252 offset:29696
  s_waitcnt lgkmcnt(4)
  v_mfma_f32_32x32x16_bf16 v[16:31], a[100:103], v[84:87], v[16:31]
  s_waitcnt vmcnt(2)
  v_mfma_f32_32x32x16_bf16 v[32:47], a[212:215], v[84:87], v[32:47]
  ds_read_b128 v[80:83], v252 offset:30720
  s_waitcnt lgkmcnt(4)
  v_mfma_f32_32x32x16_bf16 v[16:31], a[104:107], v[88:91], v[16:31]
  s_waitcnt vmcnt(1)
  v_mfma_f32_32x32x16_bf16 v[32:47], a[216:219], v[88:91], v[32:47]
  ds_read_b128 v[84:87], v252 offset:31744
  s_waitcnt lgkmcnt(4)
  v_mfma_f32_32x32x16_bf16 v[16:31], a[108:111], v[92:95], v[16:31]
  s_waitcnt vmcnt(0)
  v_mfma_f32_32x32x16_bf16 v[32:47], a[220:223], v[92:95], v[32:47]
  ds_read_b128 v[88:91], v252 offset:32768
  s_waitcnt lgkmcnt(4)
  v_mfma_f32_32x32x16_bf16 v[48:63], a[0:3], v[96:99], 0
  v_mfma_f32_32x32x16_bf16 v[64:79], a[112:115], v[96:99], 0
  ds_read_b128 v[92:95], v252 offset:33792
  s_waitcnt lgkmcnt(4)
  v_mfma_f32_32x32x16_bf16 v[48:63], a[4:7], v[100:103], v[48:63]
  v_mfma_f32_32x32x16_bf16 v[64:79], a[116:119], v[100:103], v[64:79]
  s_nop 1
  v_mul_f32 v4, s36, v16
  buffer_load_dwordx4 v[112:115], v14, s[8:11], s52 offen offset:0
  ds_read_b128 v[96:99], v252 offset:34816
  s_waitcnt lgkmcnt(4)
  v_mfma_f32_32x32x16_bf16 v[48:63], a[8:11], v[80:83], v[48:63]
  v_mul_f32 v5, s36, v17
  v_exp_f32 v4, v4
  v_exp_f32 v5, v5
  v_mfma_f32_32x32x16_bf16 v[64:79], a[120:123], v[80:83], v[64:79]
  v_mul_f32 v6, s36, v18
  v_mul_f32 v7, s36, v19
  ds_read_b128 v[100:103], v252 offset:35840
  s_waitcnt lgkmcnt(4)
  v_mfma_f32_32x32x16_bf16 v[48:63], a[12:15], v[84:87], v[48:63]
  v_mul_f32 v24, v24, v16
  buffer_load_dwordx4 v[116:119], v14, s[8:11], s53 offen offset:0
  v_mul_f32 v25, v25, v17
  v_mfma_f32_32x32x16_bf16 v[64:79], a[124:127], v[84:87], v[64:79]
  v_exp_f32 v6, v6
  ds_read_b128 v[80:83], v252 offset:36864
  s_waitcnt lgkmcnt(4)
  v_mfma_f32_32x32x16_bf16 v[48:63], a[16:19], v[88:91], v[48:63]
  v_exp_f32 v7, v7
  v_add_f32 v4, 1.0, v4
  v_add_f32 v5, 1.0, v5
  v_mfma_f32_32x32x16_bf16 v[64:79], a[128:131], v[88:91], v[64:79]
  v_mul_f32 v8, s36, v20
  v_mul_f32 v9, s36, v21
  buffer_load_dwordx4 v[120:123], v14, s[8:11], s52 offen offset:1024
  ds_read_b128 v[84:87], v252 offset:37888
  s_waitcnt lgkmcnt(4)
  v_mfma_f32_32x32x16_bf16 v[48:63], a[20:23], v[92:95], v[48:63]
  v_mul_f32 v26, v26, v18
  v_mul_f32 v27, v27, v19
  v_rcp_f32 v4, v4
  v_mfma_f32_32x32x16_bf16 v[64:79], a[132:135], v[92:95], v[64:79]
  v_rcp_f32 v5, v5
  ds_read_b128 v[88:91], v252 offset:38912
  s_waitcnt lgkmcnt(4)
  v_mfma_f32_32x32x16_bf16 v[48:63], a[24:27], v[96:99], v[48:63]
  v_exp_f32 v8, v8
  v_exp_f32 v9, v9
  v_mfma_f32_32x32x16_bf16 v[64:79], a[136:139], v[96:99], v[64:79]
  buffer_load_dwordx4 v[124:127], v14, s[8:11], s53 offen offset:1024
  v_add_f32 v6, 1.0, v6
  ds_read_b128 v[92:95], v252 offset:39936
  s_waitcnt lgkmcnt(4)
  v_mfma_f32_32x32x16_bf16 v[48:63], a[28:31], v[100:103], v[48:63]
  v_add_f32 v7, 1.0, v7
  v_mul_f32 v10, s36, v22
  v_mul_f32 v11, s36, v23
  v_mul_f32 v28, v28, v20
  v_mfma_f32_32x32x16_bf16 v[64:79], a[140:143], v[100:103], v[64:79]
  v_mul_f32 v29, v29, v21
  ds_read_b128 v[96:99], v252 offset:40960
  s_waitcnt lgkmcnt(4)
  v_mfma_f32_32x32x16_bf16 v[48:63], a[32:35], v[80:83], v[48:63]
  v_rcp_f32 v6, v6
  buffer_load_dwordx4 v[128:131], v14, s[8:11], s52 offen offset:2048
  v_rcp_f32 v7, v7
  v_mfma_f32_32x32x16_bf16 v[64:79], a[144:147], v[80:83], v[64:79]
  v_mul_f32 v24, v24, v4
  v_mul_f32 v25, v25, v5
  ds_read_b128 v[100:103], v252 offset:41984
  s_waitcnt lgkmcnt(4)
  v_mfma_f32_32x32x16_bf16 v[48:63], a[36:39], v[84:87], v[48:63]
  v_cvt_pk_bf16_f32 v104, v24, v25
  v_exp_f32 v10, v10
  v_mfma_f32_32x32x16_bf16 v[64:79], a[148:151], v[84:87], v[64:79]
  v_exp_f32 v11, v11
  buffer_load_dwordx4 v[132:135], v14, s[8:11], s53 offen offset:2048
  ds_read_b128 v[80:83], v252 offset:43008
  s_waitcnt lgkmcnt(4)
  v_mfma_f32_32x32x16_bf16 v[48:63], a[40:43], v[88:91], v[48:63]
  v_add_f32 v8, 1.0, v8
  v_add_f32 v9, 1.0, v9
  v_mul_f32 v30, v30, v22
  v_mul_f32 v31, v31, v23
  v_mfma_f32_32x32x16_bf16 v[64:79], a[152:155], v[88:91], v[64:79]
  v_rcp_f32 v8, v8
  ds_read_b128 v[84:87], v252 offset:44032
  s_waitcnt lgkmcnt(4)
  v_mfma_f32_32x32x16_bf16 v[48:63], a[44:47], v[92:95], v[48:63]
  v_rcp_f32 v9, v9
  v_mul_f32 v26, v26, v6
  buffer_load_dwordx4 v[136:139], v14, s[8:11], s52 offen offset:3072
  v_mfma_f32_32x32x16_bf16 v[64:79], a[156:159], v[92:95], v[64:79]
  v_mul_f32 v27, v27, v7
  v_cvt_pk_bf16_f32 v105, v26, v27
  ds_read_b128 v[88:91], v252 offset:45056
  s_waitcnt lgkmcnt(4)
  v_mfma_f32_32x32x16_bf16 v[48:63], a[48:51], v[96:99], v[48:63]
  v_add_f32 v10, 1.0, v10
  v_add_f32 v11, 1.0, v11
  v_rcp_f32 v10, v10
  v_mfma_f32_32x32x16_bf16 v[64:79], a[160:163], v[96:99], v[64:79]
  v_rcp_f32 v11, v11
  ds_read_b128 v[92:95], v252 offset:46080
  s_waitcnt lgkmcnt(4)
  v_mfma_f32_32x32x16_bf16 v[48:63], a[52:55], v[100:103], v[48:63]
  v_mul_f32 v28, v28, v8
  buffer_load_dwordx4 v[140:143], v14, s[8:11], s53 offen offset:3072
  v_mul_f32 v29, v29, v9
  v_cvt_pk_bf16_f32 v106, v28, v29
  v_mfma_f32_32x32x16_bf16 v[64:79], a[164:167], v[100:103], v[64:79]
  v_mul_f32 v30, v30, v10
  v_mul_f32 v31, v31, v11
  ds_read_b128 v[96:99], v252 offset:47104
  s_waitcnt lgkmcnt(4)
  v_mfma_f32_32x32x16_bf16 v[48:63], a[56:59], v[80:83], v[48:63]
  v_cvt_pk_bf16_f32 v107, v30, v31
  buffer_store_dwordx4 v[104:107], v252, s[8:11], s40 offen sc1
  s_add_u32 s40, s40, 114688
  v_mul_f32 v4, s36, v32
  v_mul_f32 v5, s36, v33
  v_mfma_f32_32x32x16_bf16 v[64:79], a[168:171], v[80:83], v[64:79]
  v_exp_f32 v4, v4
  s_add_u32 s66, s52, 4096
  ds_read_b128 v[100:103], v252 offset:48128
  s_waitcnt lgkmcnt(4)
  v_mfma_f32_32x32x16_bf16 v[48:63], a[60:63], v[84:87], v[48:63]
  v_exp_f32 v5, v5
  buffer_load_dwordx4 v[144:147], v14, s[8:11], s66 offen offset:0
  v_mul_f32 v6, s36, v34
  v_mfma_f32_32x32x16_bf16 v[64:79], a[172:175], v[84:87], v[64:79]
  v_mul_f32 v7, s36, v35
  v_mul_f32 v40, v40, v32
  ds_read_b128 v[80:83], v252 offset:49152
  s_waitcnt lgkmcnt(4)
  v_mfma_f32_32x32x16_bf16 v[48:63], a[64:67], v[88:91], v[48:63]
  v_mul_f32 v41, v41, v33
  v_exp_f32 v6, v6
  v_mfma_f32_32x32x16_bf16 v[64:79], a[176:179], v[88:91], v[64:79]
  v_exp_f32 v7, v7
  s_add_u32 s66, s53, 4096
  s_barrier
  ds_read_b128 v[84:87], v252 offset:50176
  s_waitcnt lgkmcnt(4)
  v_mfma_f32_32x32x16_bf16 v[48:63], a[68:71], v[92:95], v[48:63]
  v_add_f32 v4, 1.0, v4
  v_add_f32 v5, 1.0, v5
  buffer_load_dwordx4 v[148:151], v14, s[8:11], s66 offen offset:0
  v_mul_f32 v8, s36, v36
  v_mfma_f32_32x32x16_bf16 v[64:79], a[180:183], v[92:95], v[64:79]
  v_mul_f32 v9, s36, v37
  v_mul_f32 v42, v42, v34
  ds_read_b128 v[88:91], v252 offset:51200
  s_waitcnt lgkmcnt(4)
  v_mfma_f32_32x32x16_bf16 v[48:63], a[72:75], v[96:99], v[48:63]
  v_mul_f32 v43, v43, v35
  v_rcp_f32 v4, v4
  v_rcp_f32 v5, v5
  v_mfma_f32_32x32x16_bf16 v[64:79], a[184:187], v[96:99], v[64:79]
  v_exp_f32 v8, v8
  ds_read_b128 v[92:95], v252 offset:52224
  s_waitcnt lgkmcnt(4)
  v_mfma_f32_32x32x16_bf16 v[48:63], a[76:79], v[100:103], v[48:63]
  s_add_u32 s66, s52, 4096
  v_exp_f32 v9, v9
  buffer_load_dwordx4 v[152:155], v14, s[8:11], s66 offen offset:1024
  v_mfma_f32_32x32x16_bf16 v[64:79], a[188:191], v[100:103], v[64:79]
  v_add_f32 v6, 1.0, v6
  v_add_f32 v7, 1.0, v7
  ds_read_b128 v[96:99], v252 offset:53248
  s_waitcnt lgkmcnt(4)
  v_mfma_f32_32x32x16_bf16 v[48:63], a[80:83], v[80:83], v[48:63]
  v_mul_f32 v10, s36, v38
  v_mul_f32 v11, s36, v39
  v_mul_f32 v44, v44, v36
  v_mul_f32 v45, v45, v37
  v_mfma_f32_32x32x16_bf16 v[64:79], a[192:195], v[80:83], v[64:79]
  v_rcp_f32 v6, v6
  s_add_u32 s66, s53, 4096
  ds_read_b128 v[100:103], v252 offset:54272
  s_waitcnt lgkmcnt(4)
  v_mfma_f32_32x32x16_bf16 v[48:63], a[84:87], v[84:87], v[48:63]
  v_rcp_f32 v7, v7
  buffer_load_dwordx4 v[156:159], v14, s[8:11], s66 offen offset:1024
  v_mul_f32 v40, v40, v4
  v_mfma_f32_32x32x16_bf16 v[64:79], a[196:199], v[84:87], v[64:79]
  v_mul_f32 v41, v41, v5
  v_cvt_pk_bf16_f32 v104, v40, v41
  ds_read_b128 v[80:83], v252 offset:55296
  s_waitcnt lgkmcnt(4)
  v_mfma_f32_32x32x16_bf16 v[48:63], a[88:91], v[88:91], v[48:63]
  v_exp_f32 v10, v10
  v_exp_f32 v11, v11
  v_mfma_f32_32x32x16_bf16 v[64:79], a[200:203], v[88:91], v[64:79]
  v_add_f32 v8, 1.0, v8
  v_add_f32 v9, 1.0, v9
  s_add_u32 s66, s52, 4096
  ds_read_b128 v[84:87], v252 offset:56320
  s_waitcnt lgkmcnt(4)
  v_mfma_f32_32x32x16_bf16 v[48:63], a[92:95], v[92:95], v[48:63]
  v_mul_f32 v46, v46, v38
  v_mul_f32 v47, v47, v39
  v_rcp_f32 v8, v8
  v_mfma_f32_32x32x16_bf16 v[64:79], a[204:207], v[92:95], v[64:79]
  buffer_load_dwordx4 v[160:163], v14, s[8:11], s66 offen offset:2048
  v_rcp_f32 v9, v9
  ds_read_b128 v[88:91], v252 offset:57344
  s_waitcnt lgkmcnt(4)
  v_mfma_f32_32x32x16_bf16 v[48:63], a[96:99], v[96:99], v[48:63]
  v_mul_f32 v42, v42, v6
  v_mul_f32 v43, v43, v7
  v_cvt_pk_bf16_f32 v105, v42, v43
  v_mfma_f32_32x32x16_bf16 v[64:79], a[208:211], v[96:99], v[64:79]
  v_add_f32 v10, 1.0, v10
  v_add_f32 v11, 1.0, v11
  ds_read_b128 v[92:95], v252 offset:58368
  s_waitcnt lgkmcnt(4)
  v_mfma_f32_32x32x16_bf16 v[48:63], a[100:103], v[100:103], v[48:63]
  v_rcp_f32 v10, v10
  s_add_u32 s66, s53, 4096
  v_rcp_f32 v11, v11
  v_mfma_f32_32x32x16_bf16 v[64:79], a[212:215], v[100:103], v[64:79]
  buffer_load_dwordx4 v[164:167], v14, s[8:11], s66 offen offset:2048
  v_mul_f32 v44, v44, v8
  ds_read_b128 v[96:99], v252 offset:59392
  s_waitcnt lgkmcnt(4)
  v_mfma_f32_32x32x16_bf16 v[48:63], a[104:107], v[80:83], v[48:63]
  v_mul_f32 v45, v45, v9
  v_cvt_pk_bf16_f32 v106, v44, v45
  v_mul_f32 v46, v46, v10
  v_mul_f32 v47, v47, v11
  v_mfma_f32_32x32x16_bf16 v[64:79], a[216:219], v[80:83], v[64:79]
  v_cvt_pk_bf16_f32 v107, v46, v47
  buffer_store_dwordx4 v[104:107], v252, s[8:11], s41 offen sc1
  s_add_u32 s41, s41, 114688
  ds_read_b128 v[100:103], v252 offset:60416
  s_waitcnt lgkmcnt(4)
  v_mfma_f32_32x32x16_bf16 v[48:63], a[108:111], v[84:87], v[48:63]
  v_mfma_f32_32x32x16_bf16 v[64:79], a[220:223], v[84:87], v[64:79]
  ds_read_b128 v[80:83], v252 offset:61440
  s_waitcnt lgkmcnt(4)
  v_mfma_f32_32x32x16_bf16 v[16:31], a[0:3], v[88:91], 0
  v_mfma_f32_32x32x16_bf16 v[32:47], a[112:115], v[88:91], 0
  ds_read_b128 v[84:87], v252 offset:62464
  s_waitcnt lgkmcnt(4)
  v_mfma_f32_32x32x16_bf16 v[16:31], a[4:7], v[92:95], v[16:31]
  v_mfma_f32_32x32x16_bf16 v[32:47], a[116:119], v[92:95], v[32:47]
  s_nop 2
  v_mul_f32 v4, s36, v48
  s_add_u32 s66, s52, 4096
  v_mul_f32 v5, s36, v49
  buffer_load_dwordx4 v[168:171], v14, s[8:11], s66 offen offset:3072
  ds_read_b128 v[88:91], v252 offset:63488
  s_waitcnt lgkmcnt(4)
  v_mfma_f32_32x32x16_bf16 v[16:31], a[8:11], v[96:99], v[16:31]
  v_exp_f32 v4, v4
  v_exp_f32 v5, v5
  v_mfma_f32_32x32x16_bf16 v[32:47], a[120:123], v[96:99], v[32:47]
  v_mul_f32 v6, s36, v50
  v_mul_f32 v7, s36, v51
  v_mul_f32 v56, v56, v48
  v_mul_f32 v57, v57, v49
  ds_read_b128 v[92:95], v252 offset:64512
  s_waitcnt lgkmcnt(4)
  v_mfma_f32_32x32x16_bf16 v[16:31], a[12:15], v[100:103], v[16:31]
  s_add_u32 s66, s53, 4096
  v_exp_f32 v6, v6
  buffer_load_dwordx4 v[172:175], v14, s[8:11], s66 offen offset:3072
  v_mfma_f32_32x32x16_bf16 v[32:47], a[124:127], v[100:103], v[32:47]
  v_exp_f32 v7, v7
  v_add_f32 v4, 1.0, v4
  v_add_f32 v5, 1.0, v5
  ds_read_b128 v[96:99], v253 offset:0
  s_waitcnt lgkmcnt(4)
  v_mfma_f32_32x32x16_bf16 v[16:31], a[16:19], v[80:83], v[16:31]
  v_mul_f32 v8, s36, v52
  v_mul_f32 v9, s36, v53
  v_mul_f32 v58, v58, v50
  s_add_u32 s66, s52, 8192
  v_mul_f32 v59, v59, v51
  v_mfma_f32_32x32x16_bf16 v[32:47], a[128:131], v[80:83], v[32:47]
  v_rcp_f32 v4, v4
  buffer_load_dwordx4 v[176:179], v14, s[8:11], s66 offen offset:0
  ds_read_b128 v[100:103], v253 offset:1024
  s_waitcnt lgkmcnt(4)
  v_mfma_f32_32x32x16_bf16 v[16:31], a[20:23], v[84:87], v[16:31]
  v_rcp_f32 v5, v5
  v_exp_f32 v8, v8
  v_exp_f32 v9, v9
  v_mfma_f32_32x32x16_bf16 v[32:47], a[132:135], v[84:87], v[32:47]
  s_add_u32 s66, s53, 8192
  v_add_f32 v6, 1.0, v6
  v_add_f32 v7, 1.0, v7
  ds_read_b128 v[80:83], v253 offset:2048
  s_waitcnt lgkmcnt(4)
  v_mfma_f32_32x32x16_bf16 v[16:31], a[24:27], v[88:91], v[16:31]
  buffer_load_dwordx4 v[180:183], v14, s[8:11], s66 offen offset:0
  v_mul_f32 v10, s36, v54
  v_mul_f32 v11, s36, v55
  v_mul_f32 v60, v60, v52
  v_mul_f32 v61, v61, v53
  v_mfma_f32_32x32x16_bf16 v[32:47], a[136:139], v[88:91], v[32:47]
  v_rcp_f32 v6, v6
  ds_read_b128 v[84:87], v253 offset:3072
  s_waitcnt lgkmcnt(4)
  v_mfma_f32_32x32x16_bf16 v[16:31], a[28:31], v[92:95], v[16:31]
  v_rcp_f32 v7, v7
  s_add_u32 s66, s52, 8192
  v_mul_f32 v56, v56, v4
  buffer_load_dwordx4 v[184:187], v14, s[8:11], s66 offen offset:1024
  v_mul_f32 v57, v57, v5
  v_mfma_f32_32x32x16_bf16 v[32:47], a[140:143], v[92:95], v[32:47]
  v_cvt_pk_bf16_f32 v104, v56, v57
  v_exp_f32 v10, v10
  ds_read_b128 v[88:91], v253 offset:4096
  s_waitcnt lgkmcnt(4)
  v_mfma_f32_32x32x16_bf16 v[16:31], a[32:35], v[96:99], v[16:31]
  v_exp_f32 v11, v11
  v_add_f32 v8, 1.0, v8
  v_add_f32 v9, 1.0, v9
  s_add_u32 s66, s53, 8192
  v_mul_f32 v62, v62, v54
  v_mfma_f32_32x32x16_bf16 v[32:47], a[144:147], v[96:99], v[32:47]
  v_mul_f32 v63, v63, v55
  buffer_load_dwordx4 v[188:191], v14, s[8:11], s66 offen offset:1024
  ds_read_b128 v[92:95], v253 offset:5120
  s_waitcnt lgkmcnt(4)
  v_mfma_f32_32x32x16_bf16 v[16:31], a[36:39], v[100:103], v[16:31]
  v_rcp_f32 v8, v8
  v_rcp_f32 v9, v9
  v_mul_f32 v58, v58, v6
  v_mfma_f32_32x32x16_bf16 v[32:47], a[148:151], v[100:103], v[32:47]
  v_mul_f32 v59, v59, v7
  v_cvt_pk_bf16_f32 v105, v58, v59
  s_add_u32 s66, s52, 8192
  v_add_f32 v10, 1.0, v10
  ds_read_b128 v[96:99], v253 offset:6144
  s_waitcnt lgkmcnt(4)
  v_mfma_f32_32x32x16_bf16 v[16:31], a[40:43], v[80:83], v[16:31]
  v_add_f32 v11, 1.0, v11
  buffer_load_dwordx4 v[192:195], v14, s[8:11], s66 offen offset:2048
  v_rcp_f32 v10, v10
  v_mfma_f32_32x32x16_bf16 v[32:47], a[152:155], v[80:83], v[32:47]
  v_rcp_f32 v11, v11
  v_mul_f32 v60, v60, v8
  v_mul_f32 v61, v61, v9
  ds_read_b128 v[100:103], v253 offset:7168
  s_waitcnt lgkmcnt(4)
  v_mfma_f32_32x32x16_bf16 v[16:31], a[44:47], v[84:87], v[16:31]
  v_cvt_pk_bf16_f32 v106, v60, v61
  s_add_u32 s66, s53, 8192
  v_mul_f32 v62, v62, v10
  v_mul_f32 v63, v63, v11
  buffer_load_dwordx4 v[196:199], v14, s[8:11], s66 offen offset:2048
  v_mfma_f32_32x32x16_bf16 v[32:47], a[156:159], v[84:87], v[32:47]
  v_cvt_pk_bf16_f32 v107, v62, v63
  buffer_store_dwordx4 v[104:107], v252, s[8:11], s40 offen sc1
  s_add_u32 s40, s40, 114688
  v_mul_f32 v4, s36, v64
  ds_read_b128 v[80:83], v253 offset:8192
  s_waitcnt lgkmcnt(4)
  v_mfma_f32_32x32x16_bf16 v[16:31], a[48:51], v[88:91], v[16:31]
  v_mul_f32 v5, s36, v65
  v_exp_f32 v4, v4
  v_exp_f32 v5, v5
  v_mfma_f32_32x32x16_bf16 v[32:47], a[160:163], v[88:91], v[32:47]
  s_add_u32 s66, s52, 8192
  v_mul_f32 v6, s36, v66
  buffer_load_dwordx4 v[200:203], v14, s[8:11], s66 offen offset:3072
  v_mul_f32 v7, s36, v67
  ds_read_b128 v[84:87], v253 offset:9216
  s_waitcnt lgkmcnt(4)
  v_mfma_f32_32x32x16_bf16 v[16:31], a[52:55], v[92:95], v[16:31]
  v_mul_f32 v72, v72, v64
  v_mul_f32 v73, v73, v65
  v_exp_f32 v6, v6
  v_mfma_f32_32x32x16_bf16 v[32:47], a[164:167], v[92:95], v[32:47]
  v_exp_f32 v7, v7
  s_add_u32 s66, s53, 8192
  v_add_f32 v4, 1.0, v4
  ds_read_b128 v[88:91], v253 offset:10240
  s_waitcnt lgkmcnt(4)
  v_mfma_f32_32x32x16_bf16 v[16:31], a[56:59], v[96:99], v[16:31]
  v_add_f32 v5, 1.0, v5
  buffer_load_dwordx4 v[204:207], v14, s[8:11], s66 offen offset:3072
  v_mul_f32 v8, s36, v68
  v_mul_f32 v9, s36, v69
  v_mul_f32 v74, v74, v66
  v_mfma_f32_32x32x16_bf16 v[32:47], a[168:171], v[96:99], v[32:47]
  v_mul_f32 v75, v75, v67
  v_rcp_f32 v4, v4
  ds_read_b128 v[92:95], v253 offset:11264
  s_waitcnt lgkmcnt(4)
  v_mfma_f32_32x32x16_bf16 v[16:31], a[60:63], v[100:103], v[16:31]
  v_rcp_f32 v5, v5
  s_add_u32 s66, s52, 12288
  v_exp_f32 v8, v8
  v_mfma_f32_32x32x16_bf16 v[32:47], a[172:175], v[100:103], v[32:47]
  buffer_load_dwordx4 v[208:211], v14, s[8:11], s66 offen offset:0
  v_exp_f32 v9, v9
  v_add_f32 v6, 1.0, v6
  ds_read_b128 v[96:99], v253 offset:12288
  s_waitcnt lgkmcnt(4)
  v_mfma_f32_32x32x16_bf16 v[16:31], a[64:67], v[80:83], v[16:31]
  v_add_f32 v7, 1.0, v7
  v_mul_f32 v10, s36, v70
  v_mul_f32 v11, s36, v71
  v_mul_f32 v76, v76, v68
  s_add_u32 s66, s53, 12288
  v_mfma_f32_32x32x16_bf16 v[32:47], a[176:179], v[80:83], v[32:47]
  v_mul_f32 v77, v77, v69
  v_rcp_f32 v6, v6
  s_barrier
  ds_read_b128 v[100:103], v253 offset:13312
  s_waitcnt lgkmcnt(4)
  v_mfma_f32_32x32x16_bf16 v[16:31], a[68:71], v[84:87], v[16:31]
  buffer_load_dwordx4 v[212:215], v14, s[8:11], s66 offen offset:0
  v_rcp_f32 v7, v7
  v_mul_f32 v72, v72, v4
  v_mfma_f32_32x32x16_bf16 v[32:47], a[180:183], v[84:87], v[32:47]
  v_mul_f32 v73, v73, v5
  v_cvt_pk_bf16_f32 v104, v72, v73
  v_exp_f32 v10, v10
  ds_read_b128 v[80:83], v253 offset:14336
  s_waitcnt lgkmcnt(4)
  v_mfma_f32_32x32x16_bf16 v[16:31], a[72:75], v[88:91], v[16:31]
  s_add_u32 s66, s52, 12288
  v_exp_f32 v11, v11
  buffer_load_dwordx4 v[216:219], v14, s[8:11], s66 offen offset:1024
  v_mfma_f32_32x32x16_bf16 v[32:47], a[184:187], v[88:91], v[32:47]
  v_add_f32 v8, 1.0, v8
  v_add_f32 v9, 1.0, v9
  v_mul_f32 v78, v78, v70
  v_mul_f32 v79, v79, v71
  ds_read_b128 v[84:87], v253 offset:15360
  s_waitcnt lgkmcnt(4)
  v_mfma_f32_32x32x16_bf16 v[16:31], a[76:79], v[92:95], v[16:31]
  v_rcp_f32 v8, v8
  s_add_u32 s66, s53, 12288
  v_rcp_f32 v9, v9
  v_mfma_f32_32x32x16_bf16 v[32:47], a[188:191], v[92:95], v[32:47]
  buffer_load_dwordx4 v[220:223], v14, s[8:11], s66 offen offset:1024
  v_mul_f32 v74, v74, v6
  v_mul_f32 v75, v75, v7
  ds_read_b128 v[88:91], v253 offset:16384
  s_waitcnt lgkmcnt(4)
  v_mfma_f32_32x32x16_bf16 v[16:31], a[80:83], v[96:99], v[16:31]
  v_cvt_pk_bf16_f32 v105, v74, v75
  v_add_f32 v10, 1.0, v10
  v_add_f32 v11, 1.0, v11
  v_rcp_f32 v10, v10
  v_mfma_f32_32x32x16_bf16 v[32:47], a[192:195], v[96:99], v[32:47]
  v_rcp_f32 v11, v11
  s_add_u32 s66, s52, 12288
  buffer_load_dwordx4 v[224:227], v14, s[8:11], s66 offen offset:2048
  ds_read_b128 v[92:95], v253 offset:17408
  s_waitcnt lgkmcnt(4)
  v_mfma_f32_32x32x16_bf16 v[16:31], a[84:87], v[100:103], v[16:31]
  v_mul_f32 v76, v76, v8
  v_mul_f32 v77, v77, v9
  v_cvt_pk_bf16_f32 v106, v76, v77
  v_mul_f32 v78, v78, v10
  v_mfma_f32_32x32x16_bf16 v[32:47], a[196:199], v[100:103], v[32:47]
  v_mul_f32 v79, v79, v11
  v_cvt_pk_bf16_f32 v107, v78, v79
  buffer_store_dwordx4 v[104:107], v252, s[8:11], s41 offen sc1
  s_add_u32 s41, s41, 114688
  ds_read_b128 v[96:99], v253 offset:18432
  s_waitcnt lgkmcnt(4)
  v_mfma_f32_32x32x16_bf16 v[16:31], a[88:91], v[80:83], v[16:31]
  v_mfma_f32_32x32x16_bf16 v[32:47], a[200:203], v[80:83], v[32:47]
  ds_read_b128 v[100:103], v253 offset:19456
  s_waitcnt lgkmcnt(4)
  v_mfma_f32_32x32x16_bf16 v[16:31], a[92:95], v[84:87], v[16:31]
  v_mfma_f32_32x32x16_bf16 v[32:47], a[204:207], v[84:87], v[32:47]
  ds_read_b128 v[80:83], v253 offset:20480
  s_waitcnt lgkmcnt(4)
  v_mfma_f32_32x32x16_bf16 v[16:31], a[96:99], v[88:91], v[16:31]
  v_mfma_f32_32x32x16_bf16 v[32:47], a[208:211], v[88:91], v[32:47]
  ds_read_b128 v[84:87], v253 offset:21504
  s_waitcnt lgkmcnt(4)
  v_mfma_f32_32x32x16_bf16 v[16:31], a[100:103], v[92:95], v[16:31]
  v_mfma_f32_32x32x16_bf16 v[32:47], a[212:215], v[92:95], v[32:47]
  ds_read_b128 v[88:91], v253 offset:22528
  s_waitcnt lgkmcnt(4)
  v_mfma_f32_32x32x16_bf16 v[16:31], a[104:107], v[96:99], v[16:31]
  v_mfma_f32_32x32x16_bf16 v[32:47], a[216:219], v[96:99], v[32:47]
  ds_read_b128 v[92:95], v253 offset:23552
  s_waitcnt lgkmcnt(4)
  v_mfma_f32_32x32x16_bf16 v[16:31], a[108:111], v[100:103], v[16:31]
  v_mfma_f32_32x32x16_bf16 v[32:47], a[220:223], v[100:103], v[32:47]
  ds_read_b128 v[96:99], v253 offset:24576
  s_waitcnt lgkmcnt(4)
  v_mfma_f32_32x32x16_bf16 v[48:63], a[0:3], v[80:83], 0
  v_mfma_f32_32x32x16_bf16 v[64:79], a[112:115], v[80:83], 0
  ds_read_b128 v[100:103], v253 offset:25600
  s_waitcnt lgkmcnt(4)
  v_mfma_f32_32x32x16_bf16 v[48:63], a[4:7], v[84:87], v[48:63]
  v_mfma_f32_32x32x16_bf16 v[64:79], a[116:119], v[84:87], v[64:79]
  s_nop 2
  v_mul_f32 v4, s36, v16
  s_add_u32 s66, s53, 12288
  v_mul_f32 v5, s36, v17
  ds_read_b128 v[80:83], v253 offset:26624
  s_waitcnt lgkmcnt(4)
  v_mfma_f32_32x32x16_bf16 v[48:63], a[8:11], v[88:91], v[48:63]
  buffer_load_dwordx4 v[228:231], v14, s[8:11], s66 offen offset:2048
  v_exp_f32 v4, v4
  v_exp_f32 v5, v5
  v_mfma_f32_32x32x16_bf16 v[64:79], a[120:123], v[88:91], v[64:79]
  v_mul_f32 v6, s36, v18
  v_mul_f32 v7, s36, v19
  ds_read_b128 v[84:87], v253 offset:27648
  s_waitcnt lgkmcnt(4)
  v_mfma_f32_32x32x16_bf16 v[48:63], a[12:15], v[92:95], v[48:63]
  v_mul_f32 v24, v24, v16
  v_mul_f32 v25, v25, v17
  s_add_u32 s66, s52, 12288
  v_exp_f32 v6, v6
  v_mfma_f32_32x32x16_bf16 v[64:79], a[124:127], v[92:95], v[64:79]
  buffer_load_dwordx4 v[232:235], v14, s[8:11], s66 offen offset:3072
  ds_read_b128 v[88:91], v253 offset:28672
  s_waitcnt lgkmcnt(4)
  v_mfma_f32_32x32x16_bf16 v[48:63], a[16:19], v[96:99], v[48:63]
  v_exp_f32 v7, v7
  v_add_f32 v4, 1.0, v4
  v_add_f32 v5, 1.0, v5
  v_mul_f32 v8, s36, v20
  v_mfma_f32_32x32x16_bf16 v[64:79], a[128:131], v[96:99], v[64:79]
  v_mul_f32 v9, s36, v21
  v_mul_f32 v26, v26, v18
  ds_read_b128 v[92:95], v253 offset:29696
  s_waitcnt lgkmcnt(4)
  v_mfma_f32_32x32x16_bf16 v[48:63], a[20:23], v[100:103], v[48:63]
  v_mul_f32 v27, v27, v19
  s_add_u32 s66, s53, 12288
  v_rcp_f32 v4, v4
  buffer_load_dwordx4 v[236:239], v14, s[8:11], s66 offen offset:3072
  v_mfma_f32_32x32x16_bf16 v[64:79], a[132:135], v[100:103], v[64:79]
  v_rcp_f32 v5, v5
  ds_read_b128 v[96:99], v253 offset:30720
  s_waitcnt lgkmcnt(4)
  v_mfma_f32_32x32x16_bf16 v[48:63], a[24:27], v[80:83], v[48:63]
  v_exp_f32 v8, v8
  v_exp_f32 v9, v9
  v_mfma_f32_32x32x16_bf16 v[64:79], a[136:139], v[80:83], v[64:79]
  v_add_f32 v6, 1.0, v6
  v_add_f32 v7, 1.0, v7
  s_add_u32 s66, s52, 16384
  ds_read_b128 v[100:103], v253 offset:31744
  s_waitcnt lgkmcnt(4)
  v_mfma_f32_32x32x16_bf16 v[48:63], a[28:31], v[84:87], v[48:63]
  v_mul_f32 v10, s36, v22
  v_mul_f32 v11, s36, v23
  buffer_load_dwordx4 v[240:243], v14, s[8:11], s66 offen offset:0
  v_mul_f32 v28, v28, v20
  v_mfma_f32_32x32x16_bf16 v[64:79], a[140:143], v[84:87], v[64:79]
  v_mul_f32 v29, v29, v21
  v_rcp_f32 v6, v6
  s_waitcnt vmcnt(4)
  s_barrier
  ds_read_b128 v[80:83], v253 offset:32768
  s_waitcnt lgkmcnt(4)
  v_mfma_f32_32x32x16_bf16 v[48:63], a[32:35], v[88:91], v[48:63]
  v_rcp_f32 v7, v7
  v_mul_f32 v24, v24, v4
  v_mfma_f32_32x32x16_bf16 v[64:79], a[144:147], v[88:91], v[64:79]
  v_mul_f32 v25, v25, v5
  s_add_u32 s66, s53, 16384
  v_cvt_pk_bf16_f32 v104, v24, v25
  ds_read_b128 v[84:87], v253 offset:33792
  s_waitcnt lgkmcnt(4)
  v_mfma_f32_32x32x16_bf16 v[48:63], a[36:39], v[92:95], v[48:63]
  v_exp_f32 v10, v10
  buffer_load_dwordx4 v[244:247], v14, s[8:11], s66 offen offset:0
  v_mfma_f32_32x32x16_bf16 v[64:79], a[148:151], v[92:95], v[64:79]
  v_exp_f32 v11, v11
  v_add_f32 v8, 1.0, v8
  v_add_f32 v9, 1.0, v9
  ds_read_b128 v[88:91], v253 offset:34816
  s_waitcnt lgkmcnt(4)
  v_mfma_f32_32x32x16_bf16 v[48:63], a[40:43], v[96:99], v[48:63]
  v_mul_f32 v30, v30, v22
  v_mul_f32 v31, v31, v23
  v_rcp_f32 v8, v8
  v_mfma_f32_32x32x16_bf16 v[64:79], a[152:155], v[96:99], v[64:79]
  s_add_u32 s66, s52, 16384
  v_rcp_f32 v9, v9
  ds_read_b128 v[92:95], v253 offset:35840
  s_waitcnt lgkmcnt(4)
  v_mfma_f32_32x32x16_bf16 v[48:63], a[44:47], v[100:103], v[48:63]
  buffer_load_dwordx4 v[248:251], v14, s[8:11], s66 offen offset:1024
  v_mul_f32 v26, v26, v6
  v_mul_f32 v27, v27, v7
  v_cvt_pk_bf16_f32 v105, v26, v27
  v_mfma_f32_32x32x16_bf16 v[64:79], a[156:159], v[100:103], v[64:79]
  v_add_f32 v10, 1.0, v10
  v_add_f32 v11, 1.0, v11
  ds_read_b128 v[96:99], v253 offset:36864
  s_waitcnt lgkmcnt(4)
  v_mfma_f32_32x32x16_bf16 v[48:63], a[48:51], v[80:83], v[48:63]
  v_rcp_f32 v10, v10
  s_add_u32 s66, s53, 16384
  v_rcp_f32 v11, v11
  v_mfma_f32_32x32x16_bf16 v[64:79], a[160:163], v[80:83], v[64:79]
  buffer_load_dwordx4 a[224:227], v14, s[8:11], s66 offen offset:1024
  v_mul_f32 v28, v28, v8
  ds_read_b128 v[100:103], v253 offset:37888
  s_waitcnt lgkmcnt(4)
  v_mfma_f32_32x32x16_bf16 v[48:63], a[52:55], v[84:87], v[48:63]
  v_mul_f32 v29, v29, v9
  v_cvt_pk_bf16_f32 v106, v28, v29
  v_mul_f32 v30, v30, v10
  v_mul_f32 v31, v31, v11
  v_mfma_f32_32x32x16_bf16 v[64:79], a[164:167], v[84:87], v[64:79]
  v_cvt_pk_bf16_f32 v107, v30, v31
  buffer_store_dwordx4 v[104:107], v252, s[8:11], s40 offen sc1
  s_add_u32 s40, s40, 114688
  ds_read_b128 v[80:83], v253 offset:38912
  s_waitcnt lgkmcnt(4)
  v_mfma_f32_32x32x16_bf16 v[48:63], a[56:59], v[88:91], v[48:63]
  v_mul_f32 v4, s36, v32
  s_add_u32 s66, s52, 16384
  v_mul_f32 v5, s36, v33
  buffer_load_dwordx4 a[228:231], v14, s[8:11], s66 offen offset:2048
  v_mfma_f32_32x32x16_bf16 v[64:79], a[168:171], v[88:91], v[64:79]
  v_exp_f32 v4, v4
  s_add_u32 s67, s53, 20480
  buffer_load_dwordx4 a[112:115], v14, s[8:11], s67 offen offset:1024
  ds_read_b128 v[84:87], v253 offset:39936
  s_waitcnt lgkmcnt(4)
  v_mfma_f32_32x32x16_bf16 v[48:63], a[60:63], v[92:95], v[48:63]
  v_exp_f32 v5, v5
  v_mul_f32 v6, s36, v34
  v_mul_f32 v7, s36, v35
  v_mfma_f32_32x32x16_bf16 v[64:79], a[172:175], v[92:95], v[64:79]
  v_mul_f32 v40, v40, v32
  v_mul_f32 v41, v41, v33
  s_add_u32 s66, s53, 16384
  s_add_u32 s67, s52, 20480
  buffer_load_dwordx4 a[116:119], v14, s[8:11], s67 offen offset:2048
  ds_read_b128 v[88:91], v253 offset:40960
  s_waitcnt lgkmcnt(4)
  v_mfma_f32_32x32x16_bf16 v[48:63], a[64:67], v[96:99], v[48:63]
  v_exp_f32 v6, v6
  buffer_load_dwordx4 a[232:235], v14, s[8:11], s66 offen offset:2048
  v_mfma_f32_32x32x16_bf16 v[64:79], a[176:179], v[96:99], v[64:79]
  v_exp_f32 v7, v7
  v_add_f32 v4, 1.0, v4
  s_add_u32 s67, s53, 20480
  buffer_load_dwordx4 a[120:123], v14, s[8:11], s67 offen offset:2048
  ds_read_b128 v[92:95], v253 offset:41984
  s_waitcnt lgkmcnt(4)
  v_mfma_f32_32x32x16_bf16 v[48:63], a[68:71], v[100:103], v[48:63]
  v_add_f32 v5, 1.0, v5
  v_mul_f32 v8, s36, v36
  v_mul_f32 v9, s36, v37
  v_mfma_f32_32x32x16_bf16 v[64:79], a[180:183], v[100:103], v[64:79]
  v_mul_f32 v42, v42, v34
  v_mul_f32 v43, v43, v35
  s_add_u32 s66, s52, 16384
  s_add_u32 s67, s52, 20480
  buffer_load_dwordx4 a[124:127], v14, s[8:11], s67 offen offset:3072
  ds_read_b128 v[96:99], v253 offset:43008
  s_waitcnt lgkmcnt(4)
  v_mfma_f32_32x32x16_bf16 v[48:63], a[72:75], v[80:83], v[48:63]
  v_rcp_f32 v4, v4
  buffer_load_dwordx4 a[236:239], v14, s[8:11], s66 offen offset:3072
  v_mfma_f32_32x32x16_bf16 v[64:79], a[184:187], v[80:83], v[64:79]
  v_rcp_f32 v5, v5
  s_add_u32 s67, s53, 20480
  buffer_load_dwordx4 a[128:131], v14, s[8:11], s67 offen offset:3072
  ds_read_b128 v[100:103], v253 offset:44032
  s_waitcnt lgkmcnt(4)
  v_mfma_f32_32x32x16_bf16 v[48:63], a[76:79], v[84:87], v[48:63]
  v_exp_f32 v8, v8
  v_exp_f32 v9, v9
  v_mfma_f32_32x32x16_bf16 v[64:79], a[188:191], v[84:87], v[64:79]
  v_add_f32 v6, 1.0, v6
  v_add_f32 v7, 1.0, v7
  s_add_u32 s67, s52, 24576
  buffer_load_dwordx4 a[132:135], v14, s[8:11], s67 offen offset:0
  ds_read_b128 v[80:83], v253 offset:45056
  s_waitcnt lgkmcnt(4)
  v_mfma_f32_32x32x16_bf16 v[48:63], a[80:83], v[88:91], v[48:63]
  s_add_u32 s66, s53, 16384
  v_mul_f32 v10, s36, v38
  v_mul_f32 v11, s36, v39
  buffer_load_dwordx4 a[240:243], v14, s[8:11], s66 offen offset:3072
  v_mul_f32 v44, v44, v36
  v_mfma_f32_32x32x16_bf16 v[64:79], a[192:195], v[88:91], v[64:79]
  v_mul_f32 v45, v45, v37
  s_add_u32 s67, s53, 24576
  buffer_load_dwordx4 a[136:139], v14, s[8:11], s67 offen offset:0
  ds_read_b128 v[84:87], v253 offset:46080
  s_waitcnt lgkmcnt(4)
  v_mfma_f32_32x32x16_bf16 v[48:63], a[84:87], v[92:95], v[48:63]
  v_rcp_f32 v6, v6
  v_rcp_f32 v7, v7
  v_mfma_f32_32x32x16_bf16 v[64:79], a[196:199], v[92:95], v[64:79]
  v_mul_f32 v40, v40, v4
  v_mul_f32 v41, v41, v5
  s_add_u32 s67, s52, 24576
  buffer_load_dwordx4 a[140:143], v14, s[8:11], s67 offen offset:1024
  ds_read_b128 v[88:91], v253 offset:47104
  s_waitcnt lgkmcnt(4)
  v_mfma_f32_32x32x16_bf16 v[48:63], a[88:91], v[96:99], v[48:63]
  s_add_u32 s66, s52, 20480
  v_cvt_pk_bf16_f32 v104, v40, v41
  v_exp_f32 v10, v10
  buffer_load_dwordx4 a[244:247], v14, s[8:11], s66 offen offset:0
  v_mfma_f32_32x32x16_bf16 v[64:79], a[200:203], v[96:99], v[64:79]
  v_exp_f32 v11, v11
  s_add_u32 s67, s53, 24576
  buffer_load_dwordx4 a[144:147], v14, s[8:11], s67 offen offset:1024
  ds_read_b128 v[92:95], v253 offset:48128
  s_waitcnt lgkmcnt(4)
  v_mfma_f32_32x32x16_bf16 v[48:63], a[92:95], v[100:103], v[48:63]
  v_add_f32 v8, 1.0, v8
  v_add_f32 v9, 1.0, v9
  v_mul_f32 v46, v46, v38
  v_mfma_f32_32x32x16_bf16 v[64:79], a[204:207], v[100:103], v[64:79]
  v_mul_f32 v47, v47, v39
  v_rcp_f32 v8, v8
  s_add_u32 s66, s53, 20480
  s_add_u32 s67, s52, 24576
  buffer_load_dwordx4 a[148:151], v14, s[8:11], s67 offen offset:2048
  s_waitcnt lgkmcnt(3)
  v_mfma_f32_32x32x16_bf16 v[48:63], a[96:99], v[80:83], v[48:63]
  v_rcp_f32 v9, v9
  buffer_load_dwordx4 a[248:251], v14, s[8:11], s66 offen offset:0
  v_mul_f32 v42, v42, v6
  v_mfma_f32_32x32x16_bf16 v[64:79], a[208:211], v[80:83], v[64:79]
  v_mul_f32 v43, v43, v7
  v_cvt_pk_bf16_f32 v105, v42, v43
  v_add_f32 v10, 1.0, v10
  s_add_u32 s67, s53, 24576
  buffer_load_dwordx4 a[152:155], v14, s[8:11], s67 offen offset:2048
  s_waitcnt lgkmcnt(2)
  v_mfma_f32_32x32x16_bf16 v[48:63], a[100:103], v[84:87], v[48:63]
  v_add_f32 v11, 1.0, v11
  v_rcp_f32 v10, v10
  s_add_u32 s66, s52, 20480
  v_mfma_f32_32x32x16_bf16 v[64:79], a[212:215], v[84:87], v[64:79]
  v_rcp_f32 v11, v11
  buffer_load_dwordx4 a[252:255], v14, s[8:11], s66 offen offset:1024
  s_add_u32 s67, s52, 24576
  buffer_load_dwordx4 a[156:159], v14, s[8:11], s67 offen offset:3072
  s_waitcnt lgkmcnt(1)
  v_mfma_f32_32x32x16_bf16 v[48:63], a[104:107], v[88:91], v[48:63]
  v_mul_f32 v44, v44, v8
  v_mul_f32 v45, v45, v9
  v_cvt_pk_bf16_f32 v106, v44, v45
  v_mul_f32 v46, v46, v10
  v_mfma_f32_32x32x16_bf16 v[64:79], a[216:219], v[88:91], v[64:79]
  v_mul_f32 v47, v47, v11
  v_cvt_pk_bf16_f32 v107, v46, v47
  buffer_store_dwordx4 v[104:107], v252, s[8:11], s41 offen sc1
  s_add_u32 s41, s41, 114688
  s_add_u32 s67, s53, 24576
  buffer_load_dwordx4 a[160:163], v14, s[8:11], s67 offen offset:3072
  s_waitcnt lgkmcnt(0)
  v_mfma_f32_32x32x16_bf16 v[48:63], a[108:111], v[92:95], v[48:63]
  v_mfma_f32_32x32x16_bf16 v[64:79], a[220:223], v[92:95], v[64:79]
  s_barrier
  s_nop 9
  v_pk_mul_f32 v[4:5], v[48:49], s[36:37] op_sel_hi:[1,0]
  v_pk_mul_f32 v[56:57], v[56:57], v[48:49]
  v_exp_f32 v4, v4
  v_exp_f32 v5, v5
  s_nop 0
  v_pk_add_f32 v[4:5], v[4:5], s[38:39] op_sel_hi:[1,0]
  buffer_load_dwordx4 a[0:3], v252, s[8:11], s30 offen offset:0 sc1
  v_rcp_f32 v4, v4
  v_rcp_f32 v5, v5
  v_pk_mul_f32 v[6:7], v[50:51], s[36:37] op_sel_hi:[1,0]
  v_pk_mul_f32 v[58:59], v[58:59], v[50:51]
  v_exp_f32 v6, v6
  v_exp_f32 v7, v7
  v_pk_mul_f32 v[56:57], v[56:57], v[4:5]
  v_cvt_pk_bf16_f32 v104, v56, v57
  buffer_load_dwordx4 a[4:7], v252, s[8:11], s30 offen offset:1024 sc1
  v_pk_add_f32 v[6:7], v[6:7], s[38:39] op_sel_hi:[1,0]
  v_rcp_f32 v6, v6
  v_rcp_f32 v7, v7
  v_pk_mul_f32 v[4:5], v[52:53], s[36:37] op_sel_hi:[1,0]
  v_pk_mul_f32 v[60:61], v[60:61], v[52:53]
  v_exp_f32 v4, v4
  v_exp_f32 v5, v5
  v_pk_mul_f32 v[58:59], v[58:59], v[6:7]
  buffer_load_dwordx4 a[8:11], v252, s[8:11], s30 offen offset:2048 sc1
  v_cvt_pk_bf16_f32 v105, v58, v59
  v_pk_add_f32 v[4:5], v[4:5], s[38:39] op_sel_hi:[1,0]
  v_rcp_f32 v4, v4
  v_rcp_f32 v5, v5
  v_pk_mul_f32 v[6:7], v[54:55], s[36:37] op_sel_hi:[1,0]
  v_pk_mul_f32 v[62:63], v[62:63], v[54:55]
  v_exp_f32 v6, v6
  v_exp_f32 v7, v7
  buffer_load_dwordx4 a[12:15], v252, s[8:11], s30 offen offset:3072 sc1
  v_pk_mul_f32 v[60:61], v[60:61], v[4:5]
  v_cvt_pk_bf16_f32 v106, v60, v61
  v_pk_add_f32 v[6:7], v[6:7], s[38:39] op_sel_hi:[1,0]
  v_rcp_f32 v6, v6
  v_rcp_f32 v7, v7
  s_nop 0
  v_pk_mul_f32 v[62:63], v[62:63], v[6:7]
  v_cvt_pk_bf16_f32 v107, v62, v63
  buffer_store_dwordx4 v[104:107], v252, s[8:11], s40 offen sc1
  s_add_u32 s40, s40, 114688
  v_pk_mul_f32 v[4:5], v[64:65], s[36:37] op_sel_hi:[1,0]
  s_add_u32 s30, s30, 4096
  buffer_load_dwordx4 a[16:19], v252, s[8:11], s30 offen offset:0 sc1
  v_pk_mul_f32 v[72:73], v[72:73], v[64:65]
  v_exp_f32 v4, v4
  v_exp_f32 v5, v5
  s_nop 0
  v_pk_add_f32 v[4:5], v[4:5], s[38:39] op_sel_hi:[1,0]
  v_rcp_f32 v4, v4
  v_rcp_f32 v5, v5
  v_pk_mul_f32 v[6:7], v[66:67], s[36:37] op_sel_hi:[1,0]
  v_pk_mul_f32 v[74:75], v[74:75], v[66:67]
  buffer_load_dwordx4 a[20:23], v252, s[8:11], s30 offen offset:1024 sc1
  v_exp_f32 v6, v6
  v_exp_f32 v7, v7
  v_pk_mul_f32 v[72:73], v[72:73], v[4:5]
  v_cvt_pk_bf16_f32 v104, v72, v73
  v_pk_add_f32 v[6:7], v[6:7], s[38:39] op_sel_hi:[1,0]
  v_rcp_f32 v6, v6
  v_rcp_f32 v7, v7
  v_pk_mul_f32 v[4:5], v[68:69], s[36:37] op_sel_hi:[1,0]
  buffer_load_dwordx4 a[24:27], v252, s[8:11], s30 offen offset:2048 sc1
  v_pk_mul_f32 v[76:77], v[76:77], v[68:69]
  v_exp_f32 v4, v4
  v_exp_f32 v5, v5
  v_pk_mul_f32 v[74:75], v[74:75], v[6:7]
  v_cvt_pk_bf16_f32 v105, v74, v75
  v_pk_add_f32 v[4:5], v[4:5], s[38:39] op_sel_hi:[1,0]
  v_rcp_f32 v4, v4
  v_rcp_f32 v5, v5
  v_pk_mul_f32 v[6:7], v[70:71], s[36:37] op_sel_hi:[1,0]
  buffer_load_dwordx4 a[28:31], v252, s[8:11], s30 offen offset:3072 sc1
  v_pk_mul_f32 v[78:79], v[78:79], v[70:71]
  v_exp_f32 v6, v6
  v_exp_f32 v7, v7
  v_pk_mul_f32 v[76:77], v[76:77], v[4:5]
  v_cvt_pk_bf16_f32 v106, v76, v77
  v_pk_add_f32 v[6:7], v[6:7], s[38:39] op_sel_hi:[1,0]
  v_rcp_f32 v6, v6
  v_rcp_f32 v7, v7
  s_nop 0
  v_pk_mul_f32 v[78:79], v[78:79], v[6:7]
  v_cvt_pk_bf16_f32 v107, v78, v79
  buffer_store_dwordx4 v[104:107], v252, s[8:11], s41 offen sc1
  s_add_u32 s41, s41, 114688
  s_branch Lp4_done
Lp4_loader:
  s_lshl_b32 s24, s56, 2
  s_add_u32 s24, s24, 25166848
  v_mov_b32 v1, 1
  v_mov_b32 v2, 0
  s_mov_b64 exec, 1
  s_cmp_eq_u32 s57, 1
  s_cbranch_scc1 Ls3_fast
  buffer_store_dword v1, v2, s[8:11], s24 offen sc1
  s_branch Ls3_st
Ls3_fast:
  buffer_store_dword v1, v2, s[8:11], s24 offen
Ls3_st:
  s_mov_b64 exec, -1
  s_lshl_b32 s24, s54, 7
  s_lshl_b32 s25, s59, 6
  s_add_u32 s24, s24, s25
  s_add_u32 s24, s24, 25166848
  v_and_b32 v2, 15, v0
  v_lshlrev_b32 v2, 2, v2
  s_mov_b32 s25, 0
Ls3_poll:
  buffer_load_dword v1, v2, s[8:11], s24 offen sc1
  s_waitcnt vmcnt(0)
  v_cmp_ne_u32 vcc, 1, v1
  s_add_u32 s25, s25, 1
  s_cmp_ge_u32 s25, 30000
  s_cbranch_scc1 Ls3_polled
  s_nop 1
  s_cbranch_vccnz Ls3_poll
Ls3_polled:
  s_barrier
  s_add_u32 s35, s32, 0
  s_mov_b32 m0, 0
  s_nop 0
  buffer_load_dwordx4 v252, s[8:11], s35 offen offset:0 sc1 lds
  buffer_load_dwordx4 v252, s[8:11], s35 offen offset:1024 sc1 lds
  buffer_load_dwordx4 v252, s[8:11], s35 offen offset:2048 sc1 lds
  buffer_load_dwordx4 v252, s[8:11], s35 offen offset:3072 sc1 lds
  s_add_u32 s35, s32, 4096
  s_mov_b32 m0, 4096
  s_nop 0
  buffer_load_dwordx4 v252, s[8:11], s35 offen offset:0 sc1 lds
  buffer_load_dwordx4 v252, s[8:11], s35 offen offset:1024 sc1 lds
  buffer_load_dwordx4 v252, s[8:11], s35 offen offset:2048 sc1 lds
  buffer_load_dwordx4 v252, s[8:11], s35 offen offset:3072 sc1 lds
  s_add_u32 s35, s32, 8192
  s_mov_b32 m0, 8192
  s_nop 0
  buffer_load_dwordx4 v252, s[8:11], s35 offen offset:0 sc1 lds
  buffer_load_dwordx4 v252, s[8:11], s35 offen offset:1024 sc1 lds
  buffer_load_dwordx4 v252, s[8:11], s35 offen offset:2048 sc1 lds
  buffer_load_dwordx4 v252, s[8:11], s35 offen offset:3072 sc1 lds
  s_add_u32 s35, s32, 12288
  s_mov_b32 m0, 12288
  s_nop 0
  buffer_load_dwordx4 v252, s[8:11], s35 offen offset:0 sc1 lds
  buffer_load_dwordx4 v252, s[8:11], s35 offen offset:1024 sc1 lds
  buffer_load_dwordx4 v252, s[8:11], s35 offen offset:2048 sc1 lds
  buffer_load_dwordx4 v252, s[8:11], s35 offen offset:3072 sc1 lds
  s_add_u32 s35, s32, 16384
  s_mov_b32 m0, 16384
  s_nop 0
  buffer_load_dwordx4 v252, s[8:11], s35 offen offset:0 sc1 lds
  buffer_load_dwordx4 v252, s[8:11], s35 offen offset:1024 sc1 lds
  buffer_load_dwordx4 v252, s[8:11], s35 offen offset:2048 sc1 lds
  buffer_load_dwordx4 v252, s[8:11], s35 offen offset:3072 sc1 lds
  s_add_u32 s35, s32, 20480
  s_mov_b32 m0, 20480
  s_nop 0
  buffer_load_dwordx4 v252, s[8:11], s35 offen offset:0 sc1 lds
  buffer_load_dwordx4 v252, s[8:11], s35 offen offset:1024 sc1 lds
  buffer_load_dwordx4 v252, s[8:11], s35 offen offset:2048 sc1 lds
  buffer_load_dwordx4 v252, s[8:11], s35 offen offset:3072 sc1 lds
  s_add_u32 s35, s32, 24576
  s_mov_b32 m0, 24576
  s_nop 0
  buffer_load_dwordx4 v252, s[8:11], s35 offen offset:0 sc1 lds
  buffer_load_dwordx4 v252, s[8:11], s35 offen offset:1024 sc1 lds
  buffer_load_dwordx4 v252, s[8:11], s35 offen offset:2048 sc1 lds
  buffer_load_dwordx4 v252, s[8:11], s35 offen offset:3072 sc1 lds
  s_add_u32 s35, s32, 28672
  s_mov_b32 m0, 28672
  s_nop 0
  buffer_load_dwordx4 v252, s[8:11], s35 offen offset:0 sc1 lds
  buffer_load_dwordx4 v252, s[8:11], s35 offen offset:1024 sc1 lds
  buffer_load_dwordx4 v252, s[8:11], s35 offen offset:2048 sc1 lds
  buffer_load_dwordx4 v252, s[8:11], s35 offen offset:3072 sc1 lds
  s_add_u32 s35, s32, 32768
  s_mov_b32 m0, 32768
  s_nop 0
  buffer_load_dwordx4 v252, s[8:11], s35 offen offset:0 sc1 lds
  buffer_load_dwordx4 v252, s[8:11], s35 offen offset:1024 sc1 lds
  buffer_load_dwordx4 v252, s[8:11], s35 offen offset:2048 sc1 lds
  buffer_load_dwordx4 v252, s[8:11], s35 offen offset:3072 sc1 lds
  s_add_u32 s35, s32, 36864
  s_mov_b32 m0, 36864
  s_nop 0
  buffer_load_dwordx4 v252, s[8:11], s35 offen offset:0 sc1 lds
  buffer_load_dwordx4 v252, s[8:11], s35 offen offset:1024 sc1 lds
  buffer_load_dwordx4 v252, s[8:11], s35 offen offset:2048 sc1 lds
  buffer_load_dwordx4 v252, s[8:11], s35 offen offset:3072 sc1 lds
  s_add_u32 s35, s32, 40960
  s_mov_b32 m0, 40960
  s_nop 0
  buffer_load_dwordx4 v252, s[8:11], s35 offen offset:0 sc1 lds
  buffer_load_dwordx4 v252, s[8:11], s35 offen offset:1024 sc1 lds
  buffer_load_dwordx4 v252, s[8:11], s35 offen offset:2048 sc1 lds
  buffer_load_dwordx4 v252, s[8:11], s35 offen offset:3072 sc1 lds
  s_add_u32 s35, s32, 45056
  s_mov_b32 m0, 45056
  s_nop 0
  buffer_load_dwordx4 v252, s[8:11], s35 offen offset:0 sc1 lds
  buffer_load_dwordx4 v252, s[8:11], s35 offen offset:1024 sc1 lds
  buffer_load_dwordx4 v252, s[8:11], s35 offen offset:2048 sc1 lds
  buffer_load_dwordx4 v252, s[8:11], s35 offen offset:3072 sc1 lds
  s_add_u32 s35, s32, 49152
  s_mov_b32 m0, 49152
  s_nop 0
  buffer_load_dwordx4 v252, s[8:11], s35 offen offset:0 sc1 lds
  buffer_load_dwordx4 v252, s[8:11], s35 offen offset:1024 sc1 lds
  buffer_load_dwordx4 v252, s[8:11], s35 offen offset:2048 sc1 lds
  buffer_load_dwordx4 v252, s[8:11], s35 offen offset:3072 sc1 lds
  s_add_u32 s35, s32, 53248
  s_mov_b32 m0, 53248
  s_nop 0
  buffer_load_dwordx4 v252, s[8:11], s35 offen offset:0 sc1 lds
  buffer_load_dwordx4 v252, s[8:11], s35 offen offset:1024 sc1 lds
  buffer_load_dwordx4 v252, s[8:11], s35 offen offset:2048 sc1 lds
  buffer_load_dwordx4 v252, s[8:11], s35 offen offset:3072 sc1 lds
  s_waitcnt vmcnt(28)
  s_barrier
  ds_read_b128 v[80:83], v252 offset:0
  ds_read_b128 v[84:87], v252 offset:1024
  ds_read_b128 v[88:91], v252 offset:2048
  ds_read_b128 v[92:95], v252 offset:3072
  ds_read_b128 v[96:99], v252 offset:4096
  s_waitcnt lgkmcnt(4)
  v_mfma_f32_32x32x16_bf16 v[16:31], a[0:3], v[80:83], 0
  s_add_u32 s35, s32, 57344
  s_mov_b32 m0, 57344
  s_nop 0
  buffer_load_dwordx4 v252, s[8:11], s35 offen offset:0 sc1 lds
  ds_read_b128 v[100:103], v252 offset:5120
  s_waitcnt lgkmcnt(4)
  v_mfma_f32_32x32x16_bf16 v[16:31], a[4:7], v[84:87], v[16:31]
  buffer_load_dwordx4 v252, s[8:11], s35 offen offset:1024 sc1 lds
  buffer_load_dwordx4 v252, s[8:11], s35 offen offset:2048 sc1 lds
  ds_read_b128 v[80:83], v252 offset:6144
  s_waitcnt lgkmcnt(4)
  v_mfma_f32_32x32x16_bf16 v[16:31], a[8:11], v[88:91], v[16:31]
  buffer_load_dwordx4 v252, s[8:11], s35 offen offset:3072 sc1 lds
  s_add_u32 s35, s32, 61440
  s_mov_b32 m0, 61440
  s_nop 0
  buffer_load_dwordx4 v252, s[8:11], s35 offen offset:0 sc1 lds
  ds_read_b128 v[84:87], v252 offset:7168
  s_waitcnt lgkmcnt(4)
  v_mfma_f32_32x32x16_bf16 v[16:31], a[12:15], v[92:95], v[16:31]
  buffer_load_dwordx4 v252, s[8:11], s35 offen offset:1024 sc1 lds
  buffer_load_dwordx4 v252, s[8:11], s35 offen offset:2048 sc1 lds
  ds_read_b128 v[88:91], v252 offset:8192
  s_waitcnt lgkmcnt(4)
  v_mfma_f32_32x32x16_bf16 v[16:31], a[16:19], v[96:99], v[16:31]
  buffer_load_dwordx4 v252, s[8:11], s35 offen offset:3072 sc1 lds
  s_add_u32 s35, s32, 65536
  s_mov_b32 m0, 65536
  ds_read_b128 v[92:95], v252 offset:9216
  s_waitcnt lgkmcnt(4)
  v_mfma_f32_32x32x16_bf16 v[16:31], a[20:23], v[100:103], v[16:31]
  buffer_load_dwordx4 v252, s[8:11], s35 offen offset:0 sc1 lds
  buffer_load_dwordx4 v252, s[8:11], s35 offen offset:1024 sc1 lds
  ds_read_b128 v[96:99], v252 offset:10240
  s_waitcnt lgkmcnt(4)
  v_mfma_f32_32x32x16_bf16 v[16:31], a[24:27], v[80:83], v[16:31]
  buffer_load_dwordx4 v252, s[8:11], s35 offen offset:2048 sc1 lds
  buffer_load_dwordx4 v252, s[8:11], s35 offen offset:3072 sc1 lds
  ds_read_b128 v[100:103], v252 offset:11264
  s_waitcnt lgkmcnt(4)
  v_mfma_f32_32x32x16_bf16 v[16:31], a[28:31], v[84:87], v[16:31]
  s_add_u32 s35, s32, 69632
  s_mov_b32 m0, 69632
  s_nop 0
  buffer_load_dwordx4 v252, s[8:11], s35 offen offset:0 sc1 lds
  ds_read_b128 v[80:83], v252 offset:12288
  s_waitcnt lgkmcnt(4)
  v_mfma_f32_32x32x16_bf16 v[16:31], a[32:35], v[88:91], v[16:31]
  buffer_load_dwordx4 v252, s[8:11], s35 offen offset:1024 sc1 lds
  buffer_load_dwordx4 v252, s[8:11], s35 offen offset:2048 sc1 lds
  ds_read_b128 v[84:87], v252 offset:13312
  s_waitcnt lgkmcnt(4)
  v_mfma_f32_32x32x16_bf16 v[16:31], a[36:39], v[92:95], v[16:31]
  buffer_load_dwordx4 v252, s[8:11], s35 offen offset:3072 sc1 lds
  s_add_u32 s35, s32, 73728
  s_mov_b32 m0, 73728
  s_nop 0
  buffer_load_dwordx4 v252, s[8:11], s35 offen offset:0 sc1 lds
  ds_read_b128 v[88:91], v252 offset:14336
  s_waitcnt lgkmcnt(4)
  v_mfma_f32_32x32x16_bf16 v[16:31], a[40:43], v[96:99], v[16:31]
  buffer_load_dwordx4 v252, s[8:11], s35 offen offset:1024 sc1 lds
  buffer_load_dwordx4 v252, s[8:11], s35 offen offset:2048 sc1 lds
  ds_read_b128 v[92:95], v252 offset:15360
  s_waitcnt lgkmcnt(4)
  v_mfma_f32_32x32x16_bf16 v[16:31], a[44:47], v[100:103], v[16:31]
  buffer_load_dwordx4 v252, s[8:11], s35 offen offset:3072 sc1 lds
  s_add_u32 s35, s32, 77824
  s_mov_b32 m0, 77824
  ds_read_b128 v[96:99], v252 offset:16384
  s_waitcnt lgkmcnt(4)
  v_mfma_f32_32x32x16_bf16 v[16:31], a[48:51], v[80:83], v[16:31]
  buffer_load_dwordx4 v252, s[8:11], s35 offen offset:0 sc1 lds
  buffer_load_dwordx4 v252, s[8:11], s35 offen offset:1024 sc1 lds
  ds_read_b128 v[100:103], v252 offset:17408
  s_waitcnt lgkmcnt(4)
  v_mfma_f32_32x32x16_bf16 v[16:31], a[52:55], v[84:87], v[16:31]
  buffer_load_dwordx4 v252, s[8:11], s35 offen offset:2048 sc1 lds
  buffer_load_dwordx4 v252, s[8:11], s35 offen offset:3072 sc1 lds
  ds_read_b128 v[80:83], v252 offset:18432
  s_waitcnt lgkmcnt(4)
  v_mfma_f32_32x32x16_bf16 v[16:31], a[56:59], v[88:91], v[16:31]
  s_add_u32 s35, s32, 81920
  s_mov_b32 m0, 81920
  s_nop 0
  buffer_load_dwordx4 v252, s[8:11], s35 offen offset:0 sc1 lds
  ds_read_b128 v[84:87], v252 offset:19456
  s_waitcnt lgkmcnt(4)
  v_mfma_f32_32x32x16_bf16 v[16:31], a[60:63], v[92:95], v[16:31]
  buffer_load_dwordx4 v252, s[8:11], s35 offen offset:1024 sc1 lds
  buffer_load_dwordx4 v252, s[8:11], s35 offen offset:2048 sc1 lds
  ds_read_b128 v[88:91], v252 offset:20480
  s_waitcnt lgkmcnt(4)
  v_mfma_f32_32x32x16_bf16 v[16:31], a[64:67], v[96:99], v[16:31]
  buffer_load_dwordx4 v252, s[8:11], s35 offen offset:3072 sc1 lds
  buffer_load_dwordx4 v[112:115], v14, s[8:11], s52 offen offset:0
  s_waitcnt vmcnt(29)
  s_barrier
  ds_read_b128 v[92:95], v252 offset:21504
  s_waitcnt lgkmcnt(4)
  v_mfma_f32_32x32x16_bf16 v[16:31], a[68:71], v[100:103], v[16:31]
  buffer_load_dwordx4 v[116:119], v14, s[8:11], s53 offen offset:0
  buffer_load_dwordx4 v[120:123], v14, s[8:11], s52 offen offset:1024
  ds_read_b128 v[96:99], v252 offset:22528
  s_waitcnt lgkmcnt(4)
  v_mfma_f32_32x32x16_bf16 v[16:31], a[72:75], v[80:83], v[16:31]
  buffer_load_dwordx4 v[124:127], v14, s[8:11], s53 offen offset:1024
  buffer_load_dwordx4 v[128:131], v14, s[8:11], s52 offen offset:2048
  ds_read_b128 v[100:103], v252 offset:23552
  s_waitcnt lgkmcnt(4)
  v_mfma_f32_32x32x16_bf16 v[16:31], a[76:79], v[84:87], v[16:31]
  buffer_load_dwordx4 v[132:135], v14, s[8:11], s53 offen offset:2048
  ds_read_b128 v[80:83], v252 offset:24576
  s_waitcnt lgkmcnt(4)
  v_mfma_f32_32x32x16_bf16 v[16:31], a[80:83], v[88:91], v[16:31]
  buffer_load_dwordx4 v[136:139], v14, s[8:11], s52 offen offset:3072
  buffer_load_dwordx4 v[140:143], v14, s[8:11], s53 offen offset:3072
  s_add_u32 s66, s52, 4096
  ds_read_b128 v[84:87], v252 offset:25600
  s_waitcnt lgkmcnt(4)
  v_mfma_f32_32x32x16_bf16 v[16:31], a[84:87], v[92:95], v[16:31]
  buffer_load_dwordx4 v[144:147], v14, s[8:11], s66 offen offset:0
  s_add_u32 s66, s53, 4096
  buffer_load_dwordx4 v[148:151], v14, s[8:11], s66 offen offset:0
  ds_read_b128 v[88:91], v252 offset:26624
  s_waitcnt lgkmcnt(4)
  v_mfma_f32_32x32x16_bf16 v[16:31], a[88:91], v[96:99], v[16:31]
  s_add_u32 s66, s52, 4096
  buffer_load_dwordx4 v[152:155], v14, s[8:11], s66 offen offset:1024
  s_add_u32 s66, s53, 4096
  ds_read_b128 v[92:95], v252 offset:27648
  s_waitcnt lgkmcnt(4)
  v_mfma_f32_32x32x16_bf16 v[16:31], a[92:95], v[100:103], v[16:31]
  buffer_load_dwordx4 v[156:159], v14, s[8:11], s66 offen offset:1024
  s_add_u32 s66, s52, 4096
  buffer_load_dwordx4 v[160:163], v14, s[8:11], s66 offen offset:2048
  ds_read_b128 v[96:99], v252 offset:28672
  s_waitcnt lgkmcnt(4)
  v_mfma_f32_32x32x16_bf16 v[16:31], a[96:99], v[80:83], v[16:31]
  s_add_u32 s66, s53, 4096
  buffer_load_dwordx4 v[164:167], v14, s[8:11], s66 offen offset:2048
  s_add_u32 s66, s52, 4096
  ds_read_b128 v[100:103], v252 offset:29696
  s_waitcnt lgkmcnt(4)
  v_mfma_f32_32x32x16_bf16 v[16:31], a[100:103], v[84:87], v[16:31]
  buffer_load_dwordx4 v[168:171], v14, s[8:11], s66 offen offset:3072
  s_add_u32 s66, s53, 4096
  buffer_load_dwordx4 v[172:175], v14, s[8:11], s66 offen offset:3072
  ds_read_b128 v[80:83], v252 offset:30720
  s_waitcnt lgkmcnt(4)
  v_mfma_f32_32x32x16_bf16 v[16:31], a[104:107], v[88:91], v[16:31]
  ds_read_b128 v[84:87], v252 offset:31744
  s_waitcnt lgkmcnt(4)
  v_mfma_f32_32x32x16_bf16 v[16:31], a[108:111], v[92:95], v[16:31]
  ds_read_b128 v[88:91], v252 offset:32768
  s_waitcnt lgkmcnt(4)
  v_mfma_f32_32x32x16_bf16 v[48:63], a[0:3], v[96:99], 0
  ds_read_b128 v[92:95], v252 offset:33792
  s_waitcnt lgkmcnt(4)
  v_mfma_f32_32x32x16_bf16 v[48:63], a[4:7], v[100:103], v[48:63]
  ds_read_b128 v[96:99], v252 offset:34816
  s_waitcnt lgkmcnt(4)
  v_mfma_f32_32x32x16_bf16 v[48:63], a[8:11], v[80:83], v[48:63]
  s_nop 2
  v_mul_f32 v4, s36, v16
  s_add_u32 s35, s32, 86016
  s_mov_b32 m0, 86016
  s_nop 0
  buffer_load_dwordx4 v252, s[8:11], s35 offen offset:0 sc1 lds
  v_mul_f32 v5, s36, v17
  buffer_load_dwordx4 v252, s[8:11], s35 offen offset:1024 sc1 lds
  ds_read_b128 v[100:103], v252 offset:35840
  s_waitcnt lgkmcnt(4)
  v_mfma_f32_32x32x16_bf16 v[48:63], a[12:15], v[84:87], v[48:63]
  v_exp_f32 v4, v4
  buffer_load_dwordx4 v252, s[8:11], s35 offen offset:2048 sc1 lds
  v_exp_f32 v5, v5
  buffer_load_dwordx4 v252, s[8:11], s35 offen offset:3072 sc1 lds
  ds_read_b128 v[80:83], v252 offset:36864
  s_waitcnt lgkmcnt(4)
  v_mfma_f32_32x32x16_bf16 v[48:63], a[16:19], v[88:91], v[48:63]
  s_add_u32 s35, s32, 90112
  s_mov_b32 m0, 90112
  v_mul_f32 v6, s36, v18
  buffer_load_dwordx4 v252, s[8:11], s35 offen offset:0 sc1 lds
  v_mul_f32 v7, s36, v19
  buffer_load_dwordx4 v252, s[8:11], s35 offen offset:1024 sc1 lds
  v_mul_f32 v24, v24, v16
  ds_read_b128 v[84:87], v252 offset:37888
  s_waitcnt lgkmcnt(4)
  v_mfma_f32_32x32x16_bf16 v[48:63], a[20:23], v[92:95], v[48:63]
  buffer_load_dwordx4 v252, s[8:11], s35 offen offset:2048 sc1 lds
  v_mul_f32 v25, v25, v17
  buffer_load_dwordx4 v252, s[8:11], s35 offen offset:3072 sc1 lds
  v_exp_f32 v6, v6
  s_add_u32 s35, s32, 94208
  ds_read_b128 v[88:91], v252 offset:38912
  s_waitcnt lgkmcnt(4)
  v_mfma_f32_32x32x16_bf16 v[48:63], a[24:27], v[96:99], v[48:63]
  s_mov_b32 m0, 94208
  s_nop 0
  buffer_load_dwordx4 v252, s[8:11], s35 offen offset:0 sc1 lds
  v_exp_f32 v7, v7
  buffer_load_dwordx4 v252, s[8:11], s35 offen offset:1024 sc1 lds
  v_add_f32 v4, 1.0, v4
  ds_read_b128 v[92:95], v252 offset:39936
  s_waitcnt lgkmcnt(4)
  v_mfma_f32_32x32x16_bf16 v[48:63], a[28:31], v[100:103], v[48:63]
  buffer_load_dwordx4 v252, s[8:11], s35 offen offset:2048 sc1 lds
  v_add_f32 v5, 1.0, v5
  buffer_load_dwordx4 v252, s[8:11], s35 offen offset:3072 sc1 lds
  v_mul_f32 v8, s36, v20
  s_add_u32 s35, s32, 98304
  s_mov_b32 m0, 98304
  v_mul_f32 v9, s36, v21
  ds_read_b128 v[96:99], v252 offset:40960
  s_waitcnt lgkmcnt(4)
  v_mfma_f32_32x32x16_bf16 v[48:63], a[32:35], v[80:83], v[48:63]
  buffer_load_dwordx4 v252, s[8:11], s35 offen offset:0 sc1 lds
  v_mul_f32 v26, v26, v18
  buffer_load_dwordx4 v252, s[8:11], s35 offen offset:1024 sc1 lds
  v_mul_f32 v27, v27, v19
  buffer_load_dwordx4 v252, s[8:11], s35 offen offset:2048 sc1 lds
  ds_read_b128 v[100:103], v252 offset:41984
  s_waitcnt lgkmcnt(4)
  v_mfma_f32_32x32x16_bf16 v[48:63], a[36:39], v[84:87], v[48:63]
  v_rcp_f32 v4, v4
  buffer_load_dwordx4 v252, s[8:11], s35 offen offset:3072 sc1 lds
  v_rcp_f32 v5, v5
  s_add_u32 s35, s32, 102400
  s_mov_b32 m0, 102400
  ds_read_b128 v[80:83], v252 offset:43008
  s_waitcnt lgkmcnt(4)
  v_mfma_f32_32x32x16_bf16 v[48:63], a[40:43], v[88:91], v[48:63]
  buffer_load_dwordx4 v252, s[8:11], s35 offen offset:0 sc1 lds
  buffer_load_dwordx4 v252, s[8:11], s35 offen offset:1024 sc1 lds
  v_exp_f32 v8, v8
  buffer_load_dwordx4 v252, s[8:11], s35 offen offset:2048 sc1 lds
  ds_read_b128 v[84:87], v252 offset:44032
  s_waitcnt lgkmcnt(4)
  v_mfma_f32_32x32x16_bf16 v[48:63], a[44:47], v[92:95], v[48:63]
  v_exp_f32 v9, v9
  buffer_load_dwordx4 v252, s[8:11], s35 offen offset:3072 sc1 lds
  s_add_u32 s35, s32, 106496
  s_mov_b32 m0, 106496
  v_add_f32 v6, 1.0, v6
  buffer_load_dwordx4 v252, s[8:11], s35 offen offset:0 sc1 lds
  ds_read_b128 v[88:91], v252 offset:45056
  s_waitcnt lgkmcnt(4)
  v_mfma_f32_32x32x16_bf16 v[48:63], a[48:51], v[96:99], v[48:63]
  v_add_f32 v7, 1.0, v7
  buffer_load_dwordx4 v252, s[8:11], s35 offen offset:1024 sc1 lds
  v_mul_f32 v10, s36, v22
  buffer_load_dwordx4 v252, s[8:11], s35 offen offset:2048 sc1 lds
  v_mul_f32 v11, s36, v23
  ds_read_b128 v[92:95], v252 offset:46080
  s_waitcnt lgkmcnt(4)
  v_mfma_f32_32x32x16_bf16 v[48:63], a[52:55], v[100:103], v[48:63]
  buffer_load_dwordx4 v252, s[8:11], s35 offen offset:3072 sc1 lds
  v_mul_f32 v28, v28, v20
  v_mul_f32 v29, v29, v21
  s_add_u32 s35, s32, 110592
  s_mov_b32 m0, 110592
  s_nop 0
  buffer_load_dwordx4 v252, s[8:11], s35 offen offset:0 sc1 lds
  v_rcp_f32 v6, v6
  ds_read_b128 v[96:99], v252 offset:47104
  s_waitcnt lgkmcnt(4)
  v_mfma_f32_32x32x16_bf16 v[48:63], a[56:59], v[80:83], v[48:63]
  buffer_load_dwordx4 v252, s[8:11], s35 offen offset:1024 sc1 lds
  v_rcp_f32 v7, v7
  buffer_load_dwordx4 v252, s[8:11], s35 offen offset:2048 sc1 lds
  buffer_load_dwordx4 v252, s[8:11], s35 offen offset:3072 sc1 lds
  ds_read_b128 v[100:103], v252 offset:48128
  s_waitcnt lgkmcnt(4)
  v_mfma_f32_32x32x16_bf16 v[48:63], a[60:63], v[84:87], v[48:63]
  v_mul_f32 v24, v24, v4
  s_add_u32 s66, s52, 8192
  buffer_load_dwordx4 v[176:179], v14, s[8:11], s66 offen offset:0
  v_mul_f32 v25, v25, v5
  v_cvt_pk_bf16_f32 v104, v24, v25
  s_add_u32 s66, s53, 8192
  ds_read_b128 v[80:83], v252 offset:49152
  s_waitcnt lgkmcnt(4)
  v_mfma_f32_32x32x16_bf16 v[48:63], a[64:67], v[88:91], v[48:63]
  buffer_load_dwordx4 v[180:183], v14, s[8:11], s66 offen offset:0
  v_exp_f32 v10, v10
  s_add_u32 s66, s52, 8192
  buffer_load_dwordx4 v[184:187], v14, s[8:11], s66 offen offset:1024
  s_waitcnt vmcnt(47)
  s_barrier
  ds_read_b128 v[84:87], v252 offset:50176
  s_waitcnt lgkmcnt(4)
  v_mfma_f32_32x32x16_bf16 v[48:63], a[68:71], v[92:95], v[48:63]
  v_exp_f32 v11, v11
  s_add_u32 s66, s53, 8192
  buffer_load_dwordx4 v[188:191], v14, s[8:11], s66 offen offset:1024
  s_add_u32 s66, s52, 8192
  v_add_f32 v8, 1.0, v8
  buffer_load_dwordx4 v[192:195], v14, s[8:11], s66 offen offset:2048
  ds_read_b128 v[88:91], v252 offset:51200
  s_waitcnt lgkmcnt(4)
  v_mfma_f32_32x32x16_bf16 v[48:63], a[72:75], v[96:99], v[48:63]
  v_add_f32 v9, 1.0, v9
  s_add_u32 s66, s53, 8192
  buffer_load_dwordx4 v[196:199], v14, s[8:11], s66 offen offset:2048
  v_mul_f32 v30, v30, v22
  s_add_u32 s66, s52, 8192
  v_mul_f32 v31, v31, v23
  ds_read_b128 v[92:95], v252 offset:52224
  s_waitcnt lgkmcnt(4)
  v_mfma_f32_32x32x16_bf16 v[48:63], a[76:79], v[100:103], v[48:63]
  buffer_load_dwordx4 v[200:203], v14, s[8:11], s66 offen offset:3072
  v_rcp_f32 v8, v8
  s_add_u32 s66, s53, 8192
  buffer_load_dwordx4 v[204:207], v14, s[8:11], s66 offen offset:3072
  s_add_u32 s66, s52, 12288
  v_rcp_f32 v9, v9
  ds_read_b128 v[96:99], v252 offset:53248
  s_waitcnt lgkmcnt(4)
  v_mfma_f32_32x32x16_bf16 v[48:63], a[80:83], v[80:83], v[48:63]
  buffer_load_dwordx4 v[208:211], v14, s[8:11], s66 offen offset:0
  s_add_u32 s66, s53, 12288
  buffer_load_dwordx4 v[212:215], v14, s[8:11], s66 offen offset:0
  v_mul_f32 v26, v26, v6
  s_add_u32 s66, s52, 12288
  v_mul_f32 v27, v27, v7
  ds_read_b128 v[100:103], v252 offset:54272
  s_waitcnt lgkmcnt(4)
  v_mfma_f32_32x32x16_bf16 v[48:63], a[84:87], v[84:87], v[48:63]
  buffer_load_dwordx4 v[216:219], v14, s[8:11], s66 offen offset:1024
  v_cvt_pk_bf16_f32 v105, v26, v27
  s_add_u32 s66, s53, 12288
  buffer_load_dwordx4 v[220:223], v14, s[8:11], s66 offen offset:1024
  v_add_f32 v10, 1.0, v10
  s_add_u32 s66, s52, 12288
  v_add_f32 v11, 1.0, v11
  ds_read_b128 v[80:83], v252 offset:55296
  s_waitcnt lgkmcnt(4)
  v_mfma_f32_32x32x16_bf16 v[48:63], a[88:91], v[88:91], v[48:63]
  buffer_load_dwordx4 v[224:227], v14, s[8:11], s66 offen offset:2048
  v_rcp_f32 v10, v10
  s_add_u32 s66, s53, 12288
  buffer_load_dwordx4 v[228:231], v14, s[8:11], s66 offen offset:2048
  ds_read_b128 v[84:87], v252 offset:56320
  s_waitcnt lgkmcnt(4)
  v_mfma_f32_32x32x16_bf16 v[48:63], a[92:95], v[92:95], v[48:63]
  v_rcp_f32 v11, v11
  s_add_u32 s66, s52, 12288
  buffer_load_dwordx4 v[232:235], v14, s[8:11], s66 offen offset:3072
  s_add_u32 s66, s53, 12288
  buffer_load_dwordx4 v[236:239], v14, s[8:11], s66 offen offset:3072
  v_mul_f32 v28, v28, v8
  v_mul_f32 v29, v29, v9
  ds_read_b128 v[88:91], v252 offset:57344
  s_waitcnt lgkmcnt(4)
  v_mfma_f32_32x32x16_bf16 v[48:63], a[96:99], v[96:99], v[48:63]
  s_add_u32 s66, s52, 16384
  buffer_load_dwordx4 v[240:243], v14, s[8:11], s66 offen offset:0
  v_cvt_pk_bf16_f32 v106, v28, v29
  s_add_u32 s66, s53, 16384
  buffer_load_dwordx4 v[244:247], v14, s[8:11], s66 offen offset:0
  v_mul_f32 v30, v30, v10
  ds_read_b128 v[92:95], v252 offset:58368
  s_waitcnt lgkmcnt(4)
  v_mfma_f32_32x32x16_bf16 v[48:63], a[100:103], v[100:103], v[48:63]
  v_mul_f32 v31, v31, v11
  s_add_u32 s66, s52, 16384
  buffer_load_dwordx4 v[248:251], v14, s[8:11], s66 offen offset:1024
  v_cvt_pk_bf16_f32 v107, v30, v31
  s_add_u32 s66, s53, 16384
  buffer_store_dwordx4 v[104:107], v252, s[8:11], s40 offen sc1
  buffer_load_dwordx4 a[224:227], v14, s[8:11], s66 offen offset:1024
  s_add_u32 s40, s40, 114688
  ds_read_b128 v[96:99], v252 offset:59392
  s_waitcnt lgkmcnt(4)
  v_mfma_f32_32x32x16_bf16 v[48:63], a[104:107], v[80:83], v[48:63]
  ds_read_b128 v[100:103], v252 offset:60416
  s_waitcnt lgkmcnt(4)
  v_mfma_f32_32x32x16_bf16 v[48:63], a[108:111], v[84:87], v[48:63]
  ds_read_b128 v[80:83], v252 offset:61440
  s_waitcnt lgkmcnt(4)
  v_mfma_f32_32x32x16_bf16 v[16:31], a[0:3], v[88:91], 0
  ds_read_b128 v[84:87], v252 offset:62464
  s_waitcnt lgkmcnt(4)
  v_mfma_f32_32x32x16_bf16 v[16:31], a[4:7], v[92:95], v[16:31]
  ds_read_b128 v[88:91], v252 offset:63488
  s_waitcnt lgkmcnt(4)
  v_mfma_f32_32x32x16_bf16 v[16:31], a[8:11], v[96:99], v[16:31]
  s_nop 2
  v_mul_f32 v4, s36, v48
  s_add_u32 s66, s52, 16384
  buffer_load_dwordx4 a[228:231], v14, s[8:11], s66 offen offset:2048
  v_mul_f32 v5, s36, v49
  v_exp_f32 v4, v4
  ds_read_b128 v[92:95], v252 offset:64512
  s_waitcnt lgkmcnt(4)
  v_mfma_f32_32x32x16_bf16 v[16:31], a[12:15], v[100:103], v[16:31]
  s_add_u32 s66, s53, 16384
  v_exp_f32 v5, v5
  buffer_load_dwordx4 a[232:235], v14, s[8:11], s66 offen offset:2048
  v_mul_f32 v6, s36, v50
  ds_read_b128 v[96:99], v253 offset:0
  s_waitcnt lgkmcnt(4)
  v_mfma_f32_32x32x16_bf16 v[16:31], a[16:19], v[80:83], v[16:31]
  s_add_u32 s66, s52, 16384
  v_mul_f32 v7, s36, v51
  buffer_load_dwordx4 a[236:239], v14, s[8:11], s66 offen offset:3072
  v_mul_f32 v56, v56, v48
  v_mul_f32 v57, v57, v49
  ds_read_b128 v[100:103], v253 offset:1024
  s_waitcnt lgkmcnt(4)
  v_mfma_f32_32x32x16_bf16 v[16:31], a[20:23], v[84:87], v[16:31]
  v_exp_f32 v6, v6
  s_add_u32 s66, s53, 16384
  buffer_load_dwordx4 a[240:243], v14, s[8:11], s66 offen offset:3072
  v_exp_f32 v7, v7
  s_add_u32 s66, s52, 20480
  ds_read_b128 v[80:83], v253 offset:2048
  s_waitcnt lgkmcnt(4)
  v_mfma_f32_32x32x16_bf16 v[16:31], a[24:27], v[88:91], v[16:31]
  v_add_f32 v4, 1.0, v4
  buffer_load_dwordx4 a[244:247], v14, s[8:11], s66 offen offset:0
  v_add_f32 v5, 1.0, v5
  v_mul_f32 v8, s36, v52
  v_mul_f32 v9, s36, v53
  ds_read_b128 v[84:87], v253 offset:3072
  s_waitcnt lgkmcnt(4)
  v_mfma_f32_32x32x16_bf16 v[16:31], a[28:31], v[92:95], v[16:31]
  s_add_u32 s66, s53, 20480
  v_mul_f32 v58, v58, v50
  buffer_load_dwordx4 a[248:251], v14, s[8:11], s66 offen offset:0
  v_mul_f32 v59, v59, v51
  v_rcp_f32 v4, v4
  ds_read_b128 v[88:91], v253 offset:4096
  s_waitcnt lgkmcnt(4)
  v_mfma_f32_32x32x16_bf16 v[16:31], a[32:35], v[96:99], v[16:31]
  s_add_u32 s66, s52, 20480
  buffer_load_dwordx4 a[252:255], v14, s[8:11], s66 offen offset:1024
  v_rcp_f32 v5, v5
  ds_read_b128 v[92:95], v253 offset:5120
  s_waitcnt lgkmcnt(4)
  v_mfma_f32_32x32x16_bf16 v[16:31], a[36:39], v[100:103], v[16:31]
  v_exp_f32 v8, v8
  s_add_u32 s66, s53, 20480
  buffer_load_dwordx4 a[112:115], v14, s[8:11], s66 offen offset:1024
  v_exp_f32 v9, v9
  s_add_u32 s66, s52, 20480
  ds_read_b128 v[96:99], v253 offset:6144
  s_waitcnt lgkmcnt(4)
  v_mfma_f32_32x32x16_bf16 v[16:31], a[40:43], v[80:83], v[16:31]
  v_add_f32 v6, 1.0, v6
  buffer_load_dwordx4 a[116:119], v14, s[8:11], s66 offen offset:2048
  v_add_f32 v7, 1.0, v7
  v_mul_f32 v10, s36, v54
  v_mul_f32 v11, s36, v55
  ds_read_b128 v[100:103], v253 offset:7168
  s_waitcnt lgkmcnt(4)
  v_mfma_f32_32x32x16_bf16 v[16:31], a[44:47], v[84:87], v[16:31]
  s_add_u32 s66, s53, 20480
  buffer_load_dwordx4 a[120:123], v14, s[8:11], s66 offen offset:2048
  v_mul_f32 v60, v60, v52
  v_mul_f32 v61, v61, v53
  v_rcp_f32 v6, v6
  ds_read_b128 v[80:83], v253 offset:8192
  s_waitcnt lgkmcnt(4)
  v_mfma_f32_32x32x16_bf16 v[16:31], a[48:51], v[88:91], v[16:31]
  s_add_u32 s66, s52, 20480
  buffer_load_dwordx4 a[124:127], v14, s[8:11], s66 offen offset:3072
  v_rcp_f32 v7, v7
  v_mul_f32 v56, v56, v4
  ds_read_b128 v[84:87], v253 offset:9216
  s_waitcnt lgkmcnt(4)
  v_mfma_f32_32x32x16_bf16 v[16:31], a[52:55], v[92:95], v[16:31]
  s_add_u32 s66, s53, 20480
  buffer_load_dwordx4 a[128:131], v14, s[8:11], s66 offen offset:3072
  v_mul_f32 v57, v57, v5
  v_cvt_pk_bf16_f32 v104, v56, v57
  v_exp_f32 v10, v10
  ds_read_b128 v[88:91], v253 offset:10240
  s_waitcnt lgkmcnt(4)
  v_mfma_f32_32x32x16_bf16 v[16:31], a[56:59], v[96:99], v[16:31]
  s_add_u32 s66, s52, 24576
  buffer_load_dwordx4 a[132:135], v14, s[8:11], s66 offen offset:0
  v_exp_f32 v11, v11
  v_add_f32 v8, 1.0, v8
  ds_read_b128 v[92:95], v253 offset:11264
  s_waitcnt lgkmcnt(4)
  v_mfma_f32_32x32x16_bf16 v[16:31], a[60:63], v[100:103], v[16:31]
  s_add_u32 s66, s53, 24576
  buffer_load_dwordx4 a[136:139], v14, s[8:11], s66 offen offset:0
  v_add_f32 v9, 1.0, v9
  v_mul_f32 v62, v62, v54
  v_mul_f32 v63, v63, v55
  s_add_u32 s66, s52, 24576
  ds_read_b128 v[96:99], v253 offset:12288
  s_waitcnt lgkmcnt(4)
  v_mfma_f32_32x32x16_bf16 v[16:31], a[64:67], v[80:83], v[16:31]
  v_rcp_f32 v8, v8
  buffer_load_dwordx4 a[140:143], v14, s[8:11], s66 offen offset:1024
  s_waitcnt vmcnt(36)
  s_barrier
  ds_read_b128 v[100:103], v253 offset:13312
  s_waitcnt lgkmcnt(4)
  v_mfma_f32_32x32x16_bf16 v[16:31], a[68:71], v[84:87], v[16:31]
  v_rcp_f32 v9, v9
  s_add_u32 s66, s53, 24576
  buffer_load_dwordx4 a[144:147], v14, s[8:11], s66 offen offset:1024
  v_mul_f32 v58, v58, v6
  v_mul_f32 v59, v59, v7
  ds_read_b128 v[80:83], v253 offset:14336
  s_waitcnt lgkmcnt(4)
  v_mfma_f32_32x32x16_bf16 v[16:31], a[72:75], v[88:91], v[16:31]
  v_cvt_pk_bf16_f32 v105, v58, v59
  s_add_u32 s66, s52, 24576
  v_add_f32 v10, 1.0, v10
  buffer_load_dwordx4 a[148:151], v14, s[8:11], s66 offen offset:2048
  v_add_f32 v11, 1.0, v11
  ds_read_b128 v[84:87], v253 offset:15360
  s_waitcnt lgkmcnt(4)
  v_mfma_f32_32x32x16_bf16 v[16:31], a[76:79], v[92:95], v[16:31]
  v_rcp_f32 v10, v10
  s_add_u32 s66, s53, 24576
  buffer_load_dwordx4 a[152:155], v14, s[8:11], s66 offen offset:2048
  v_rcp_f32 v11, v11
  ds_read_b128 v[88:91], v253 offset:16384
  s_waitcnt lgkmcnt(4)
  v_mfma_f32_32x32x16_bf16 v[16:31], a[80:83], v[96:99], v[16:31]
  v_mul_f32 v60, v60, v8
  s_add_u32 s66, s52, 24576
  v_mul_f32 v61, v61, v9
  buffer_load_dwordx4 a[156:159], v14, s[8:11], s66 offen offset:3072
  v_cvt_pk_bf16_f32 v106, v60, v61
  v_mul_f32 v62, v62, v10
  ds_read_b128 v[92:95], v253 offset:17408
  s_waitcnt lgkmcnt(4)
  v_mfma_f32_32x32x16_bf16 v[16:31], a[84:87], v[100:103], v[16:31]
  s_add_u32 s66, s53, 24576
  v_mul_f32 v63, v63, v11
  buffer_load_dwordx4 a[160:163], v14, s[8:11], s66 offen offset:3072
  v_cvt_pk_bf16_f32 v107, v62, v63
  buffer_store_dwordx4 v[104:107], v252, s[8:11], s40 offen sc1
  s_add_u32 s40, s40, 114688
  ds_read_b128 v[96:99], v253 offset:18432
  s_waitcnt lgkmcnt(4)
  v_mfma_f32_32x32x16_bf16 v[16:31], a[88:91], v[80:83], v[16:31]
  ds_read_b128 v[100:103], v253 offset:19456
  s_waitcnt lgkmcnt(4)
  v_mfma_f32_32x32x16_bf16 v[16:31], a[92:95], v[84:87], v[16:31]
  ds_read_b128 v[80:83], v253 offset:20480
  s_waitcnt lgkmcnt(4)
  v_mfma_f32_32x32x16_bf16 v[16:31], a[96:99], v[88:91], v[16:31]
  ds_read_b128 v[84:87], v253 offset:21504
  s_waitcnt lgkmcnt(4)
  v_mfma_f32_32x32x16_bf16 v[16:31], a[100:103], v[92:95], v[16:31]
  ds_read_b128 v[88:91], v253 offset:22528
  s_waitcnt lgkmcnt(4)
  v_mfma_f32_32x32x16_bf16 v[16:31], a[104:107], v[96:99], v[16:31]
  ds_read_b128 v[92:95], v253 offset:23552
  s_waitcnt lgkmcnt(4)
  v_mfma_f32_32x32x16_bf16 v[16:31], a[108:111], v[100:103], v[16:31]
  ds_read_b128 v[96:99], v253 offset:24576
  s_waitcnt lgkmcnt(4)
  v_mfma_f32_32x32x16_bf16 v[48:63], a[0:3], v[80:83], 0
  ds_read_b128 v[100:103], v253 offset:25600
  s_waitcnt lgkmcnt(4)
  v_mfma_f32_32x32x16_bf16 v[48:63], a[4:7], v[84:87], v[48:63]
  ds_read_b128 v[80:83], v253 offset:26624
  s_waitcnt lgkmcnt(4)
  v_mfma_f32_32x32x16_bf16 v[48:63], a[8:11], v[88:91], v[48:63]
  s_nop 2
  v_mul_f32 v4, s36, v16
  v_mul_f32 v5, s36, v17
  ds_read_b128 v[84:87], v253 offset:27648
  s_waitcnt lgkmcnt(4)
  v_mfma_f32_32x32x16_bf16 v[48:63], a[12:15], v[92:95], v[48:63]
  v_exp_f32 v4, v4
  v_exp_f32 v5, v5
  ds_read_b128 v[88:91], v253 offset:28672
  s_waitcnt lgkmcnt(4)
  v_mfma_f32_32x32x16_bf16 v[48:63], a[16:19], v[96:99], v[48:63]
  v_mul_f32 v6, s36, v18
  v_mul_f32 v7, s36, v19
  ds_read_b128 v[92:95], v253 offset:29696
  s_waitcnt lgkmcnt(4)
  v_mfma_f32_32x32x16_bf16 v[48:63], a[20:23], v[100:103], v[48:63]
  v_mul_f32 v24, v24, v16
  v_mul_f32 v25, v25, v17
  v_exp_f32 v6, v6
  ds_read_b128 v[96:99], v253 offset:30720
  s_waitcnt lgkmcnt(4)
  v_mfma_f32_32x32x16_bf16 v[48:63], a[24:27], v[80:83], v[48:63]
  v_exp_f32 v7, v7
  ds_read_b128 v[100:103], v253 offset:31744
  s_waitcnt lgkmcnt(4)
  v_mfma_f32_32x32x16_bf16 v[48:63], a[28:31], v[84:87], v[48:63]
  v_add_f32 v4, 1.0, v4
  v_add_f32 v5, 1.0, v5
  s_waitcnt vmcnt(0)
  s_barrier
  s_lshl_b32 s24, s56, 2
  s_add_u32 s24, s24, 25167872
  v_mov_b32 v1, 1
  v_mov_b32 v2, 0
  s_mov_b64 exec, 1
  s_cmp_eq_u32 s57, 1
  s_cbranch_scc1 Lf4a_fast
  buffer_store_dword v1, v2, s[8:11], s24 offen sc1
  s_branch Lf4a_st
Lf4a_fast:
  buffer_store_dword v1, v2, s[8:11], s24 offen
Lf4a_st:
  s_mov_b64 exec, -1
  ds_read_b128 v[80:83], v253 offset:32768
  s_waitcnt lgkmcnt(4)
  v_mfma_f32_32x32x16_bf16 v[48:63], a[32:35], v[88:91], v[48:63]
  v_mul_f32 v8, s36, v20
  v_mul_f32 v9, s36, v21
  ds_read_b128 v[84:87], v253 offset:33792
  s_waitcnt lgkmcnt(4)
  v_mfma_f32_32x32x16_bf16 v[48:63], a[36:39], v[92:95], v[48:63]
  v_mul_f32 v26, v26, v18
  v_mul_f32 v27, v27, v19
  v_rcp_f32 v4, v4
  ds_read_b128 v[88:91], v253 offset:34816
  s_waitcnt lgkmcnt(4)
  v_mfma_f32_32x32x16_bf16 v[48:63], a[40:43], v[96:99], v[48:63]
  v_rcp_f32 v5, v5
  ds_read_b128 v[92:95], v253 offset:35840
  s_waitcnt lgkmcnt(4)
  v_mfma_f32_32x32x16_bf16 v[48:63], a[44:47], v[100:103], v[48:63]
  v_exp_f32 v8, v8
  ds_read_b128 v[96:99], v253 offset:36864
  s_waitcnt lgkmcnt(4)
  v_mfma_f32_32x32x16_bf16 v[48:63], a[48:51], v[80:83], v[48:63]
  v_exp_f32 v9, v9
  v_add_f32 v6, 1.0, v6
  ds_read_b128 v[100:103], v253 offset:37888
  s_waitcnt lgkmcnt(4)
  v_mfma_f32_32x32x16_bf16 v[48:63], a[52:55], v[84:87], v[48:63]
  v_add_f32 v7, 1.0, v7
  v_mul_f32 v10, s36, v22
  v_mul_f32 v11, s36, v23
  ds_read_b128 v[80:83], v253 offset:38912
  s_waitcnt lgkmcnt(4)
  v_mfma_f32_32x32x16_bf16 v[48:63], a[56:59], v[88:91], v[48:63]
  v_mul_f32 v28, v28, v20
  v_mul_f32 v29, v29, v21
  ds_read_b128 v[84:87], v253 offset:39936
  s_waitcnt lgkmcnt(4)
  v_mfma_f32_32x32x16_bf16 v[48:63], a[60:63], v[92:95], v[48:63]
  v_rcp_f32 v6, v6
  v_rcp_f32 v7, v7
  ds_read_b128 v[88:91], v253 offset:40960
  s_waitcnt lgkmcnt(4)
  v_mfma_f32_32x32x16_bf16 v[48:63], a[64:67], v[96:99], v[48:63]
  v_mul_f32 v24, v24, v4
  v_mul_f32 v25, v25, v5
  ds_read_b128 v[92:95], v253 offset:41984
  s_waitcnt lgkmcnt(4)
  v_mfma_f32_32x32x16_bf16 v[48:63], a[68:71], v[100:103], v[48:63]
  v_cvt_pk_bf16_f32 v104, v24, v25
  v_exp_f32 v10, v10
  ds_read_b128 v[96:99], v253 offset:43008
  s_waitcnt lgkmcnt(4)
  v_mfma_f32_32x32x16_bf16 v[48:63], a[72:75], v[80:83], v[48:63]
  v_exp_f32 v11, v11
  v_add_f32 v8, 1.0, v8
  ds_read_b128 v[100:103], v253 offset:44032
  s_waitcnt lgkmcnt(4)
  v_mfma_f32_32x32x16_bf16 v[48:63], a[76:79], v[84:87], v[48:63]
  v_add_f32 v9, 1.0, v9
  v_mul_f32 v30, v30, v22
  v_mul_f32 v31, v31, v23
  ds_read_b128 v[80:83], v253 offset:45056
  s_waitcnt lgkmcnt(4)
  v_mfma_f32_32x32x16_bf16 v[48:63], a[80:83], v[88:91], v[48:63]
  v_rcp_f32 v8, v8
  ds_read_b128 v[84:87], v253 offset:46080
  s_waitcnt lgkmcnt(4)
  v_mfma_f32_32x32x16_bf16 v[48:63], a[84:87], v[92:95], v[48:63]
  v_rcp_f32 v9, v9
  v_mul_f32 v26, v26, v6
  ds_read_b128 v[88:91], v253 offset:47104
  s_waitcnt lgkmcnt(4)
  v_mfma_f32_32x32x16_bf16 v[48:63], a[88:91], v[96:99], v[48:63]
  v_mul_f32 v27, v27, v7
  v_cvt_pk_bf16_f32 v105, v26, v27
  v_add_f32 v10, 1.0, v10
  ds_read_b128 v[92:95], v253 offset:48128
  s_waitcnt lgkmcnt(4)
  v_mfma_f32_32x32x16_bf16 v[48:63], a[92:95], v[100:103], v[48:63]
  v_add_f32 v11, 1.0, v11
  v_rcp_f32 v10, v10
  s_waitcnt lgkmcnt(3)
  v_mfma_f32_32x32x16_bf16 v[48:63], a[96:99], v[80:83], v[48:63]
  v_rcp_f32 v11, v11
  v_mul_f32 v28, v28, v8
  v_mul_f32 v29, v29, v9
  v_cvt_pk_bf16_f32 v106, v28, v29
  s_waitcnt lgkmcnt(2)
  v_mfma_f32_32x32x16_bf16 v[48:63], a[100:103], v[84:87], v[48:63]
  v_mul_f32 v30, v30, v10
  v_mul_f32 v31, v31, v11
  v_cvt_pk_bf16_f32 v107, v30, v31
  buffer_store_dwordx4 v[104:107], v252, s[8:11], s40 offen sc1
  s_add_u32 s40, s40, 114688
  s_waitcnt lgkmcnt(1)
  v_mfma_f32_32x32x16_bf16 v[48:63], a[104:107], v[88:91], v[48:63]
  s_waitcnt lgkmcnt(0)
  v_mfma_f32_32x32x16_bf16 v[48:63], a[108:111], v[92:95], v[48:63]
  s_lshl_b32 s24, s54, 7
  s_lshl_b32 s25, s64, 6
  s_add_u32 s24, s24, s25
  s_add_u32 s24, s24, 25167872
  v_and_b32 v2, 15, v0
  v_lshlrev_b32 v2, 2, v2
  s_mov_b32 s25, 0
Lf4a_poll:
  buffer_load_dword v1, v2, s[8:11], s24 offen sc1
  s_waitcnt vmcnt(0)
  v_cmp_ne_u32 vcc, 1, v1
  s_add_u32 s25, s25, 1
  s_cmp_ge_u32 s25, 30000
  s_nop 2
  s_cbranch_scc1 Lf4a_polled
  s_cbranch_vccnz Lf4a_poll
Lf4a_polled:
  s_barrier
  v_pk_mul_f32 v[4:5], v[48:49], s[36:37] op_sel_hi:[1,0]
  v_pk_mul_f32 v[56:57], v[56:57], v[48:49]
  v_exp_f32 v4, v4
  buffer_load_dwordx4 a[0:3], v252, s[8:11], s30 offen offset:0 sc1
  v_exp_f32 v5, v5
  s_nop 0
  v_pk_add_f32 v[4:5], v[4:5], s[38:39] op_sel_hi:[1,0]
  v_rcp_f32 v4, v4
  v_rcp_f32 v5, v5
  buffer_load_dwordx4 a[4:7], v252, s[8:11], s30 offen offset:1024 sc1
  v_pk_mul_f32 v[6:7], v[50:51], s[36:37] op_sel_hi:[1,0]
  v_pk_mul_f32 v[58:59], v[58:59], v[50:51]
  v_exp_f32 v6, v6
  v_exp_f32 v7, v7
  buffer_load_dwordx4 a[8:11], v252, s[8:11], s30 offen offset:2048 sc1
  v_pk_mul_f32 v[56:57], v[56:57], v[4:5]
  v_cvt_pk_bf16_f32 v104, v56, v57
  v_pk_add_f32 v[6:7], v[6:7], s[38:39] op_sel_hi:[1,0]
  v_rcp_f32 v6, v6
  v_rcp_f32 v7, v7
  buffer_load_dwordx4 a[12:15], v252, s[8:11], s30 offen offset:3072 sc1
  v_pk_mul_f32 v[4:5], v[52:53], s[36:37] op_sel_hi:[1,0]
  v_pk_mul_f32 v[60:61], v[60:61], v[52:53]
  v_exp_f32 v4, v4
  v_exp_f32 v5, v5
  v_pk_mul_f32 v[58:59], v[58:59], v[6:7]
  s_add_u32 s30, s30, 4096
  buffer_load_dwordx4 a[16:19], v252, s[8:11], s30 offen offset:0 sc1
  v_cvt_pk_bf16_f32 v105, v58, v59
  v_pk_add_f32 v[4:5], v[4:5], s[38:39] op_sel_hi:[1,0]
  v_rcp_f32 v4, v4
  v_rcp_f32 v5, v5
  v_pk_mul_f32 v[6:7], v[54:55], s[36:37] op_sel_hi:[1,0]
  buffer_load_dwordx4 a[20:23], v252, s[8:11], s30 offen offset:1024 sc1
  v_pk_mul_f32 v[62:63], v[62:63], v[54:55]
  v_exp_f32 v6, v6
  v_exp_f32 v7, v7
  v_pk_mul_f32 v[60:61], v[60:61], v[4:5]
  buffer_load_dwordx4 a[24:27], v252, s[8:11], s30 offen offset:2048 sc1
  v_cvt_pk_bf16_f32 v106, v60, v61
  v_pk_add_f32 v[6:7], v[6:7], s[38:39] op_sel_hi:[1,0]
  v_rcp_f32 v6, v6
  v_rcp_f32 v7, v7
  s_nop 0
  v_pk_mul_f32 v[62:63], v[62:63], v[6:7]
  buffer_load_dwordx4 a[28:31], v252, s[8:11], s30 offen offset:3072 sc1
  v_cvt_pk_bf16_f32 v107, v62, v63
  buffer_store_dwordx4 v[104:107], v252, s[8:11], s40 offen sc1
  s_add_u32 s40, s40, 114688
  v_mov_b32 v4, 2146435072
  buffer_store_dword v4, v4, s[8:11], 0 offen
Lp4_done:
  s_cmp_ge_u32 s55, 28
  s_cbranch_scc0 Lk2_p5
  s_waitcnt vmcnt(0)
  s_barrier
  s_cmp_lg_u32 s23, 3
  s_cbranch_scc1 Lk2_end
  s_lshl_b32 s24, s56, 2
  s_add_u32 s24, s24, 25168896
  v_mov_b32 v1, 1
  v_mov_b32 v2, 0
  s_mov_b64 exec, 1
  s_cmp_eq_u32 s57, 1
  s_cbranch_scc1 Lf4bx_fast
  buffer_store_dword v1, v2, s[8:11], s24 offen sc1
  s_branch Lf4bx_st
Lf4bx_fast:
  buffer_store_dword v1, v2, s[8:11], s24 offen
Lf4bx_st:
  s_mov_b64 exec, -1
  s_branch Lk2_end
Lk2_p5:
  s_lshl_b32 s38, s46, 5
  s_mul_i32 s38, s38, 896
  s_lshl_b32 s39, s61, 7
  s_add_u32 s38, s38, s39
  s_lshl_b32 s44, s23, 6
  v_add_u32 v3, s44, v0
  v_lshrrev_b32 v4, 3, v3
  v_and_b32 v5, 7, v3
  v_mul_u32_u24 v10, 896, v4
  v_lshl_add_u32 v10, v5, 4, v10
  v_mul_u32_u24 v11, 272, v4
  v_lshl_add_u32 v11, v5, 5, v11
  v_and_b32 v3, 31, v0
  v_lshrrev_b32 v4, 5, v0
  v_mul_u32_u24 v12, 272, v3
  v_lshl_add_u32 v12, v4, 4, v12
  s_lshl_b32 s44, s23, 5
  v_add_u32 v12, s44, v12
  s_add_u32 s39, s38, 6291456
  s_add_u32 s47, s38, 57344
  s_add_u32 s48, s39, 57344
  s_add_u32 s44, s23, 1
  s_and_b32 s44, s44, 3
  s_mul_i32 s44, s44, 12288
  s_add_u32 s44, s44, 0
  v_add_u32 v6, s44, v252
  s_add_u32 s44, s23, 2
  s_and_b32 s44, s44, 3
  s_mul_i32 s44, s44, 12288
  s_add_u32 s44, s44, 1024
  v_add_u32 v7, s44, v252
  s_add_u32 s44, s23, 3
  s_and_b32 s44, s44, 3
  s_mul_i32 s44, s44, 12288
  s_add_u32 s44, s44, 2048
  v_add_u32 v8, s44, v252
  s_mul_i32 s44, s23, 12288
  v_add_u32 v9, s44, v252
  s_waitcnt vmcnt(7)
  v_mfma_f32_32x32x16_bf16 v[16:31], v[112:115], a[0:3], 0
  v_mfma_f32_32x32x16_bf16 v[32:47], v[116:119], a[0:3], 0
  s_add_u32 s30, s30, 4096
  buffer_load_dwordx4 a[32:35], v252, s[8:11], s30 offen offset:0 sc1
  buffer_load_dwordx4 a[36:39], v252, s[8:11], s30 offen offset:1024 sc1
  s_waitcnt vmcnt(8)
  v_mfma_f32_32x32x16_bf16 v[16:31], v[120:123], a[4:7], v[16:31]
  v_mfma_f32_32x32x16_bf16 v[32:47], v[124:127], a[4:7], v[32:47]
  buffer_load_dwordx4 a[40:43], v252, s[8:11], s30 offen offset:2048 sc1
  buffer_load_dwordx4 a[44:47], v252, s[8:11], s30 offen offset:3072 sc1
  s_waitcnt vmcnt(9)
  v_mfma_f32_32x32x16_bf16 v[16:31], v[128:131], a[8:11], v[16:31]
  v_mfma_f32_32x32x16_bf16 v[32:47], v[132:135], a[8:11], v[32:47]
  s_add_u32 s30, s30, 4096
  buffer_load_dwordx4 a[48:51], v252, s[8:11], s30 offen offset:0 sc1
  buffer_load_dwordx4 a[52:55], v252, s[8:11], s30 offen offset:1024 sc1
  s_waitcnt vmcnt(10)
  v_mfma_f32_32x32x16_bf16 v[16:31], v[136:139], a[12:15], v[16:31]
  v_mfma_f32_32x32x16_bf16 v[32:47], v[140:143], a[12:15], v[32:47]
  buffer_load_dwordx4 a[56:59], v252, s[8:11], s30 offen offset:2048 sc1
  buffer_load_dwordx4 a[60:63], v252, s[8:11], s30 offen offset:3072 sc1
  s_waitcnt vmcnt(11)
  v_mfma_f32_32x32x16_bf16 v[16:31], v[144:147], a[16:19], v[16:31]
  v_mfma_f32_32x32x16_bf16 v[32:47], v[148:151], a[16:19], v[32:47]
  s_add_u32 s30, s30, 4096
  buffer_load_dwordx4 a[64:67], v252, s[8:11], s30 offen offset:0 sc1
  s_waitcnt vmcnt(11)
  v_mfma_f32_32x32x16_bf16 v[16:31], v[152:155], a[20:23], v[16:31]
  v_mfma_f32_32x32x16_bf16 v[32:47], v[156:159], a[20:23], v[32:47]
  buffer_load_dwordx4 a[68:71], v252, s[8:11], s30 offen offset:1024 sc1
  s_waitcnt vmcnt(11)
  v_mfma_f32_32x32x16_bf16 v[16:31], v[160:163], a[24:27], v[16:31]
  v_mfma_f32_32x32x16_bf16 v[32:47], v[164:167], a[24:27], v[32:47]
  s_waitcnt vmcnt(10)
  s_barrier
  s_cmp_lg_u32 s23, 3
  s_cbranch_scc1 Lhf_skip
  s_lshl_b32 s24, s56, 2
  s_add_u32 s24, s24, 25168896
  v_mov_b32 v1, 1
  v_mov_b32 v2, 0
  s_mov_b64 exec, 1
  s_cmp_eq_u32 s57, 1
  s_cbranch_scc1 Lf4b_fast
  buffer_store_dword v1, v2, s[8:11], s24 offen sc1
  s_branch Lf4b_st
Lf4b_fast:
  buffer_store_dword v1, v2, s[8:11], s24 offen
Lf4b_st:
  s_mov_b64 exec, -1
Lhf_skip:
  buffer_load_dwordx4 a[72:75], v252, s[8:11], s30 offen offset:2048 sc1
  v_mfma_f32_32x32x16_bf16 v[16:31], v[168:171], a[28:31], v[16:31]
  v_mfma_f32_32x32x16_bf16 v[32:47], v[172:175], a[28:31], v[32:47]
  buffer_load_dwordx4 a[76:79], v252, s[8:11], s30 offen offset:3072 sc1
  s_waitcnt vmcnt(11)
  v_mfma_f32_32x32x16_bf16 v[16:31], v[176:179], a[32:35], v[16:31]
  v_mfma_f32_32x32x16_bf16 v[32:47], v[180:183], a[32:35], v[32:47]
  s_add_u32 s30, s30, 4096
  buffer_load_dwordx4 a[80:83], v252, s[8:11], s30 offen offset:0 sc1
  s_waitcnt vmcnt(11)
  v_mfma_f32_32x32x16_bf16 v[16:31], v[184:187], a[36:39], v[16:31]
  v_mfma_f32_32x32x16_bf16 v[32:47], v[188:191], a[36:39], v[32:47]
  buffer_load_dwordx4 a[84:87], v252, s[8:11], s30 offen offset:1024 sc1
  s_waitcnt vmcnt(11)
  v_mfma_f32_32x32x16_bf16 v[16:31], v[192:195], a[40:43], v[16:31]
  v_mfma_f32_32x32x16_bf16 v[32:47], v[196:199], a[40:43], v[32:47]
  buffer_load_dwordx4 a[88:91], v252, s[8:11], s30 offen offset:2048 sc1
  s_waitcnt vmcnt(11)
  v_mfma_f32_32x32x16_bf16 v[16:31], v[200:203], a[44:47], v[16:31]
  v_mfma_f32_32x32x16_bf16 v[32:47], v[204:207], a[44:47], v[32:47]
  buffer_load_dwordx4 a[92:95], v252, s[8:11], s30 offen offset:3072 sc1
  s_waitcnt vmcnt(11)
  v_mfma_f32_32x32x16_bf16 v[16:31], v[208:211], a[48:51], v[16:31]
  v_mfma_f32_32x32x16_bf16 v[32:47], v[212:215], a[48:51], v[32:47]
  s_cmp_lg_u32 s23, 3
  s_cbranch_scc1 Lhi_skip
  s_lshl_b32 s24, s54, 7
  s_lshl_b32 s25, s64, 6
  s_add_u32 s24, s24, s25
  s_add_u32 s24, s24, 25168896
  v_and_b32 v2, 15, v0
  v_lshlrev_b32 v2, 2, v2
  s_mov_b32 s25, 0
  buffer_load_dword v1, v2, s[8:11], s24 offen sc1
Lhi_skip:
  s_add_u32 s30, s30, 4096
  buffer_load_dwordx4 a[96:99], v252, s[8:11], s30 offen offset:0 sc1
  s_waitcnt vmcnt(11)
  v_mfma_f32_32x32x16_bf16 v[16:31], v[216:219], a[52:55], v[16:31]
  v_mfma_f32_32x32x16_bf16 v[32:47], v[220:223], a[52:55], v[32:47]
  buffer_load_dwordx4 a[100:103], v252, s[8:11], s30 offen offset:1024 sc1
  s_waitcnt vmcnt(11)
  v_mfma_f32_32x32x16_bf16 v[16:31], v[224:227], a[56:59], v[16:31]
  v_mfma_f32_32x32x16_bf16 v[32:47], v[228:231], a[56:59], v[32:47]
  buffer_load_dwordx4 a[104:107], v252, s[8:11], s30 offen offset:2048 sc1
  s_waitcnt vmcnt(11)
  v_mfma_f32_32x32x16_bf16 v[16:31], v[232:235], a[60:63], v[16:31]
  v_mfma_f32_32x32x16_bf16 v[32:47], v[236:239], a[60:63], v[32:47]
  buffer_load_dwordx4 a[108:111], v252, s[8:11], s30 offen offset:3072 sc1
  s_waitcnt vmcnt(11)
  v_mfma_f32_32x32x16_bf16 v[16:31], v[240:243], a[64:67], v[16:31]
  v_mfma_f32_32x32x16_bf16 v[32:47], v[244:247], a[64:67], v[32:47]
  s_waitcnt vmcnt(10)
  v_mfma_f32_32x32x16_bf16 v[16:31], v[248:251], a[68:71], v[16:31]
  v_mfma_f32_32x32x16_bf16 v[32:47], a[224:227], a[68:71], v[32:47]
  s_waitcnt vmcnt(9)
  v_mfma_f32_32x32x16_bf16 v[16:31], a[228:231], a[72:75], v[16:31]
  v_mfma_f32_32x32x16_bf16 v[32:47], a[232:235], a[72:75], v[32:47]
  s_waitcnt vmcnt(8)
  v_mfma_f32_32x32x16_bf16 v[16:31], a[236:239], a[76:79], v[16:31]
  v_mfma_f32_32x32x16_bf16 v[32:47], a[240:243], a[76:79], v[32:47]
  s_waitcnt vmcnt(7)
  v_mfma_f32_32x32x16_bf16 v[16:31], a[244:247], a[80:83], v[16:31]
  v_mfma_f32_32x32x16_bf16 v[32:47], a[248:251], a[80:83], v[32:47]
  s_waitcnt vmcnt(6)
  v_mfma_f32_32x32x16_bf16 v[16:31], a[252:255], a[84:87], v[16:31]
  v_mfma_f32_32x32x16_bf16 v[32:47], a[112:115], a[84:87], v[32:47]
  s_waitcnt vmcnt(5)
  v_mfma_f32_32x32x16_bf16 v[16:31], a[116:119], a[88:91], v[16:31]
  v_mfma_f32_32x32x16_bf16 v[32:47], a[120:123], a[88:91], v[32:47]
  s_cmp_lg_u32 s23, 3
  s_cbranch_scc1 Lhc_skip
  s_waitcnt vmcnt(0)
  v_cmp_ne_u32 vcc, 1, v1
  s_nop 4
  s_cbranch_vccz Lf4b_polled
Lf4b_poll:
  buffer_load_dword v1, v2, s[8:11], s24 offen sc1
  s_waitcnt vmcnt(0)
  v_cmp_ne_u32 vcc, 1, v1
  s_add_u32 s25, s25, 1
  s_cmp_ge_u32 s25, 30000
  s_nop 2
  s_cbranch_scc1 Lf4b_polled
  s_cbranch_vccnz Lf4b_poll
Lf4b_polled:
Lhc_skip:
  s_barrier
  buffer_load_dwordx4 a[0:3], v252, s[8:11], s31 offen offset:0 sc1
  buffer_load_dwordx4 a[4:7], v252, s[8:11], s31 offen offset:1024 sc1
  s_waitcnt vmcnt(6)
  v_mfma_f32_32x32x16_bf16 v[16:31], a[124:127], a[92:95], v[16:31]
  v_mfma_f32_32x32x16_bf16 v[32:47], a[128:131], a[92:95], v[32:47]
  buffer_load_dwordx4 a[8:11], v252, s[8:11], s31 offen offset:2048 sc1
  buffer_load_dwordx4 a[12:15], v252, s[8:11], s31 offen offset:3072 sc1
  s_waitcnt vmcnt(7)
  v_mfma_f32_32x32x16_bf16 v[16:31], a[132:135], a[96:99], v[16:31]
  v_mfma_f32_32x32x16_bf16 v[32:47], a[136:139], a[96:99], v[32:47]
  s_add_u32 s31, s31, 4096
  buffer_load_dwordx4 a[16:19], v252, s[8:11], s31 offen offset:0 sc1
  buffer_load_dwordx4 a[20:23], v252, s[8:11], s31 offen offset:1024 sc1
  s_waitcnt vmcnt(8)
  v_mfma_f32_32x32x16_bf16 v[16:31], a[140:143], a[100:103], v[16:31]
  v_mfma_f32_32x32x16_bf16 v[32:47], a[144:147], a[100:103], v[32:47]
  buffer_load_dwordx4 a[24:27], v252, s[8:11], s31 offen offset:2048 sc1
  buffer_load_dwordx4 a[28:31], v252, s[8:11], s31 offen offset:3072 sc1
  s_waitcnt vmcnt(9)
  v_mfma_f32_32x32x16_bf16 v[16:31], a[148:151], a[104:107], v[16:31]
  v_mfma_f32_32x32x16_bf16 v[32:47], a[152:155], a[104:107], v[32:47]
  s_add_u32 s31, s31, 4096
  buffer_load_dwordx4 a[32:35], v252, s[8:11], s31 offen offset:0 sc1
  buffer_load_dwordx4 a[36:39], v252, s[8:11], s31 offen offset:1024 sc1
  s_waitcnt vmcnt(10)
  v_mfma_f32_32x32x16_bf16 v[16:31], a[156:159], a[108:111], v[16:31]
  v_mfma_f32_32x32x16_bf16 v[32:47], a[160:163], a[108:111], v[32:47]
  buffer_load_dwordx4 a[40:43], v252, s[8:11], s31 offen offset:2048 sc1
  buffer_load_dwordx4 a[44:47], v252, s[8:11], s31 offen offset:3072 sc1
  s_waitcnt vmcnt(11)
  v_mfma_f32_32x32x16_bf16 v[48:63], v[112:115], a[0:3], 0
  v_mfma_f32_32x32x16_bf16 v[64:79], v[116:119], a[0:3], 0
  s_add_u32 s31, s31, 4096
  buffer_load_dwordx4 a[48:51], v252, s[8:11], s31 offen offset:0 sc1
  s_waitcnt vmcnt(11)
  v_mfma_f32_32x32x16_bf16 v[48:63], v[120:123], a[4:7], v[48:63]
  v_mfma_f32_32x32x16_bf16 v[64:79], v[124:127], a[4:7], v[64:79]
  buffer_load_dwordx4 a[52:55], v252, s[8:11], s31 offen offset:1024 sc1
  s_waitcnt vmcnt(11)
  v_mfma_f32_32x32x16_bf16 v[48:63], v[128:131], a[8:11], v[48:63]
  v_mfma_f32_32x32x16_bf16 v[64:79], v[132:135], a[8:11], v[64:79]
  buffer_load_dwordx4 a[56:59], v252, s[8:11], s31 offen offset:2048 sc1
  s_waitcnt vmcnt(11)
  v_mfma_f32_32x32x16_bf16 v[48:63], v[136:139], a[12:15], v[48:63]
  ds_write_b128 v6, v[20:23] offset:0
  v_mfma_f32_32x32x16_bf16 v[64:79], v[140:143], a[12:15], v[64:79]
  buffer_load_dwordx4 a[60:63], v252, s[8:11], s31 offen offset:3072 sc1
  s_waitcnt vmcnt(11)
  v_mfma_f32_32x32x16_bf16 v[48:63], v[144:147], a[16:19], v[48:63]
  v_mfma_f32_32x32x16_bf16 v[64:79], v[148:151], a[16:19], v[64:79]
  s_add_u32 s31, s31, 4096
  buffer_load_dwordx4 a[64:67], v252, s[8:11], s31 offen offset:0 sc1
  s_waitcnt vmcnt(11)
  v_mfma_f32_32x32x16_bf16 v[48:63], v[152:155], a[20:23], v[48:63]
  ds_write_b128 v7, v[24:27] offset:0
  v_mfma_f32_32x32x16_bf16 v[64:79], v[156:159], a[20:23], v[64:79]
  buffer_load_dwordx4 a[68:71], v252, s[8:11], s31 offen offset:1024 sc1
  s_waitcnt vmcnt(11)
  v_mfma_f32_32x32x16_bf16 v[48:63], v[160:163], a[24:27], v[48:63]
  v_mfma_f32_32x32x16_bf16 v[64:79], v[164:167], a[24:27], v[64:79]
  buffer_load_dwordx4 a[72:75], v252, s[8:11], s31 offen offset:2048 sc1
  s_waitcnt vmcnt(11)
  v_mfma_f32_32x32x16_bf16 v[48:63], v[168:171], a[28:31], v[48:63]
  ds_write_b128 v8, v[28:31] offset:0
  v_mfma_f32_32x32x16_bf16 v[64:79], v[172:175], a[28:31], v[64:79]
  buffer_load_dwordx4 a[76:79], v252, s[8:11], s31 offen offset:3072 sc1
  s_waitcnt vmcnt(11)
  v_mfma_f32_32x32x16_bf16 v[48:63], v[176:179], a[32:35], v[48:63]
  v_mfma_f32_32x32x16_bf16 v[64:79], v[180:183], a[32:35], v[64:79]
  s_add_u32 s31, s31, 4096
  buffer_load_dwordx4 a[80:83], v252, s[8:11], s31 offen offset:0 sc1
  s_waitcnt vmcnt(11)
  v_mfma_f32_32x32x16_bf16 v[48:63], v[184:187], a[36:39], v[48:63]
  v_mfma_f32_32x32x16_bf16 v[64:79], v[188:191], a[36:39], v[64:79]
  ds_write_b128 v6, v[36:39] offset:3072
  buffer_load_dwordx4 a[84:87], v252, s[8:11], s31 offen offset:1024 sc1
  s_waitcnt vmcnt(11)
  v_mfma_f32_32x32x16_bf16 v[48:63], v[192:195], a[40:43], v[48:63]
  v_mfma_f32_32x32x16_bf16 v[64:79], v[196:199], a[40:43], v[64:79]
  buffer_load_dwordx4 a[88:91], v252, s[8:11], s31 offen offset:2048 sc1
  s_waitcnt vmcnt(11)
  v_mfma_f32_32x32x16_bf16 v[48:63], v[200:203], a[44:47], v[48:63]
  v_mfma_f32_32x32x16_bf16 v[64:79], v[204:207], a[44:47], v[64:79]
  ds_write_b128 v7, v[40:43] offset:3072
  buffer_load_dwordx4 a[92:95], v252, s[8:11], s31 offen offset:3072 sc1
  s_waitcnt vmcnt(11)
  v_mfma_f32_32x32x16_bf16 v[48:63], v[208:211], a[48:51], v[48:63]
  v_mfma_f32_32x32x16_bf16 v[64:79], v[212:215], a[48:51], v[64:79]
  s_add_u32 s31, s31, 4096
  buffer_load_dwordx4 a[96:99], v252, s[8:11], s31 offen offset:0 sc1
  s_waitcnt vmcnt(11)
  v_mfma_f32_32x32x16_bf16 v[48:63], v[216:219], a[52:55], v[48:63]
  v_mfma_f32_32x32x16_bf16 v[64:79], v[220:223], a[52:55], v[64:79]
  ds_write_b128 v8, v[44:47] offset:3072
  buffer_load_dwordx4 a[100:103], v252, s[8:11], s31 offen offset:1024 sc1
  s_waitcnt vmcnt(11)
  v_mfma_f32_32x32x16_bf16 v[48:63], v[224:227], a[56:59], v[48:63]
  v_mfma_f32_32x32x16_bf16 v[64:79], v[228:231], a[56:59], v[64:79]
  buffer_load_dwordx4 a[104:107], v252, s[8:11], s31 offen offset:2048 sc1
  s_waitcnt vmcnt(11)
  v_mfma_f32_32x32x16_bf16 v[48:63], v[232:235], a[60:63], v[48:63]
  v_mfma_f32_32x32x16_bf16 v[64:79], v[236:239], a[60:63], v[64:79]
  buffer_load_dwordx4 a[108:111], v252, s[8:11], s31 offen offset:3072 sc1
  s_waitcnt vmcnt(11)
  v_mfma_f32_32x32x16_bf16 v[48:63], v[240:243], a[64:67], v[48:63]
  v_mfma_f32_32x32x16_bf16 v[64:79], v[244:247], a[64:67], v[64:79]
  buffer_load_dwordx4 v[80:83], v10, s[8:11], s39 offen sc1
  buffer_load_dwordx4 v[84:87], v10, s[8:11], s48 offen sc1
  s_waitcnt vmcnt(12)
  v_mfma_f32_32x32x16_bf16 v[48:63], v[248:251], a[68:71], v[48:63]
  v_mfma_f32_32x32x16_bf16 v[64:79], a[224:227], a[68:71], v[64:79]
  s_waitcnt vmcnt(11)
  v_mfma_f32_32x32x16_bf16 v[48:63], a[228:231], a[72:75], v[48:63]
  v_mfma_f32_32x32x16_bf16 v[64:79], a[232:235], a[72:75], v[64:79]
  s_waitcnt vmcnt(10)
  v_mfma_f32_32x32x16_bf16 v[48:63], a[236:239], a[76:79], v[48:63]
  v_mfma_f32_32x32x16_bf16 v[64:79], a[240:243], a[76:79], v[64:79]
  s_waitcnt vmcnt(9)
  v_mfma_f32_32x32x16_bf16 v[48:63], a[244:247], a[80:83], v[48:63]
  v_mfma_f32_32x32x16_bf16 v[64:79], a[248:251], a[80:83], v[64:79]
  s_waitcnt vmcnt(8)
  v_mfma_f32_32x32x16_bf16 v[48:63], a[252:255], a[84:87], v[48:63]
  v_mfma_f32_32x32x16_bf16 v[64:79], a[112:115], a[84:87], v[64:79]
  s_waitcnt vmcnt(7)
  v_mfma_f32_32x32x16_bf16 v[48:63], a[116:119], a[88:91], v[48:63]
  v_mfma_f32_32x32x16_bf16 v[64:79], a[120:123], a[88:91], v[64:79]
  s_waitcnt vmcnt(6)
  v_mfma_f32_32x32x16_bf16 v[48:63], a[124:127], a[92:95], v[48:63]
  v_mfma_f32_32x32x16_bf16 v[64:79], a[128:131], a[92:95], v[64:79]
  s_waitcnt vmcnt(5)
  v_mfma_f32_32x32x16_bf16 v[48:63], a[132:135], a[96:99], v[48:63]
  v_mfma_f32_32x32x16_bf16 v[64:79], a[136:139], a[96:99], v[64:79]
  s_waitcnt vmcnt(4)
  v_mfma_f32_32x32x16_bf16 v[48:63], a[140:143], a[100:103], v[48:63]
  v_mfma_f32_32x32x16_bf16 v[64:79], a[144:147], a[100:103], v[64:79]
  s_waitcnt vmcnt(3)
  v_mfma_f32_32x32x16_bf16 v[48:63], a[148:151], a[104:107], v[48:63]
  v_mfma_f32_32x32x16_bf16 v[64:79], a[152:155], a[104:107], v[64:79]
  s_waitcnt vmcnt(2)
  v_mfma_f32_32x32x16_bf16 v[48:63], a[156:159], a[108:111], v[48:63]
  v_mfma_f32_32x32x16_bf16 v[64:79], a[160:163], a[108:111], v[64:79]
  s_nop 10
  ds_write_b128 v6, v[52:55] offset:6144
  ds_write_b128 v7, v[56:59] offset:6144
  ds_write_b128 v8, v[60:63] offset:6144
  ds_write_b128 v6, v[68:71] offset:9216
  ds_write_b128 v7, v[72:75] offset:9216
  ds_write_b128 v8, v[76:79] offset:9216
  s_waitcnt vmcnt(1)
  v_lshlrev_b32 v88, 16, v80
  v_and_b32 v89, 0xffff0000, v80
  v_lshlrev_b32 v90, 16, v81
  v_and_b32 v91, 0xffff0000, v81
  v_lshlrev_b32 v92, 16, v82
  v_and_b32 v93, 0xffff0000, v82
  v_lshlrev_b32 v94, 16, v83
  v_and_b32 v95, 0xffff0000, v83
  s_waitcnt vmcnt(0)
  v_lshlrev_b32 v96, 16, v84
  v_and_b32 v97, 0xffff0000, v84
  v_lshlrev_b32 v98, 16, v85
  v_and_b32 v99, 0xffff0000, v85
  v_lshlrev_b32 v100, 16, v86
  v_and_b32 v101, 0xffff0000, v86
  v_lshlrev_b32 v102, 16, v87
  v_and_b32 v103, 0xffff0000, v87
  s_waitcnt lgkmcnt(0)
  s_barrier
  ds_read_b128 v[112:115], v9 offset:0
  ds_read_b128 v[116:119], v9 offset:1024
  ds_read_b128 v[120:123], v9 offset:2048
  ds_read_b128 v[124:127], v9 offset:3072
  ds_read_b128 v[128:131], v9 offset:4096
  ds_read_b128 v[132:135], v9 offset:5120
  ds_read_b128 v[136:139], v9 offset:6144
  ds_read_b128 v[140:143], v9 offset:7168
  ds_read_b128 v[144:147], v9 offset:8192
  ds_read_b128 v[148:151], v9 offset:9216
  ds_read_b128 v[152:155], v9 offset:10240
  ds_read_b128 v[156:159], v9 offset:11264
  s_waitcnt lgkmcnt(11)
  v_pk_add_f32 v[16:17], v[16:17], v[112:113]
  v_pk_add_f32 v[18:19], v[18:19], v[114:115]
  s_waitcnt lgkmcnt(10)
  v_pk_add_f32 v[16:17], v[16:17], v[116:117]
  v_pk_add_f32 v[18:19], v[18:19], v[118:119]
  s_waitcnt lgkmcnt(9)
  v_pk_add_f32 v[16:17], v[16:17], v[120:121]
  v_pk_add_f32 v[18:19], v[18:19], v[122:123]
  ds_write_b128 v12, v[16:19] offset:49152
  s_waitcnt lgkmcnt(9)
  v_pk_add_f32 v[32:33], v[32:33], v[124:125]
  v_pk_add_f32 v[34:35], v[34:35], v[126:127]
  s_waitcnt lgkmcnt(8)
  v_pk_add_f32 v[32:33], v[32:33], v[128:129]
  v_pk_add_f32 v[34:35], v[34:35], v[130:131]
  s_waitcnt lgkmcnt(7)
  v_pk_add_f32 v[32:33], v[32:33], v[132:133]
  v_pk_add_f32 v[34:35], v[34:35], v[134:135]
  ds_write_b128 v12, v[32:35] offset:49280
  s_waitcnt lgkmcnt(7)
  v_pk_add_f32 v[48:49], v[48:49], v[136:137]
  v_pk_add_f32 v[50:51], v[50:51], v[138:139]
  s_waitcnt lgkmcnt(6)
  v_pk_add_f32 v[48:49], v[48:49], v[140:141]
  v_pk_add_f32 v[50:51], v[50:51], v[142:143]
  s_waitcnt lgkmcnt(5)
  v_pk_add_f32 v[48:49], v[48:49], v[144:145]
  v_pk_add_f32 v[50:51], v[50:51], v[146:147]
  ds_write_b128 v12, v[48:51] offset:57856
  s_waitcnt lgkmcnt(5)
  v_pk_add_f32 v[64:65], v[64:65], v[148:149]
  v_pk_add_f32 v[66:67], v[66:67], v[150:151]
  s_waitcnt lgkmcnt(4)
  v_pk_add_f32 v[64:65], v[64:65], v[152:153]
  v_pk_add_f32 v[66:67], v[66:67], v[154:155]
  s_waitcnt lgkmcnt(3)
  v_pk_add_f32 v[64:65], v[64:65], v[156:157]
  v_pk_add_f32 v[66:67], v[66:67], v[158:159]
  ds_write_b128 v12, v[64:67] offset:57984
  s_waitcnt lgkmcnt(0)
  s_barrier
  ds_read_b128 v[160:163], v11 offset:49152
  ds_read_b128 v[164:167], v11 offset:49168
  ds_read_b128 v[168:171], v11 offset:57856
  ds_read_b128 v[172:175], v11 offset:57872
  s_waitcnt lgkmcnt(3)
  v_pk_add_f32 v[160:161], v[160:161], v[88:89]
  v_pk_add_f32 v[162:163], v[162:163], v[90:91]
  s_waitcnt lgkmcnt(2)
  v_pk_add_f32 v[164:165], v[164:165], v[92:93]
  v_pk_add_f32 v[166:167], v[166:167], v[94:95]
  v_cvt_pk_bf16_f32 v104, v160, v161
  v_cvt_pk_bf16_f32 v105, v162, v163
  v_cvt_pk_bf16_f32 v106, v164, v165
  v_cvt_pk_bf16_f32 v107, v166, v167
  buffer_store_dwordx4 v[104:107], v10, s[12:15], s38 offen
  s_waitcnt lgkmcnt(1)
  v_pk_add_f32 v[168:169], v[168:169], v[96:97]
  v_pk_add_f32 v[170:171], v[170:171], v[98:99]
  s_waitcnt lgkmcnt(0)
  v_pk_add_f32 v[172:173], v[172:173], v[100:101]
  v_pk_add_f32 v[174:175], v[174:175], v[102:103]
  v_cvt_pk_bf16_f32 v108, v168, v169
  v_cvt_pk_bf16_f32 v109, v170, v171
  v_cvt_pk_bf16_f32 v110, v172, v173
  v_cvt_pk_bf16_f32 v111, v174, v175
  buffer_store_dwordx4 v[108:111], v10, s[12:15], s47 offen
Lk2_end:
  s_endpgm
Lk2_codeend:
.section .rodata,"a"
.p2align 6
.amdhsa_kernel k1_kernel
  .amdhsa_next_free_vgpr 252
  .amdhsa_next_free_sgpr 102
  .amdhsa_accum_offset 252
  .amdhsa_group_segment_fixed_size 0
  .amdhsa_kernarg_size 80
  .amdhsa_user_sgpr_count 2
  .amdhsa_user_sgpr_kernarg_segment_ptr 1
  .amdhsa_system_sgpr_workgroup_id_x 1
.end_amdhsa_kernel
.p2align 6
.amdhsa_kernel k2_kernel
  .amdhsa_next_free_vgpr 512
  .amdhsa_next_free_sgpr 102
  .amdhsa_accum_offset 256
  .amdhsa_group_segment_fixed_size 0
  .amdhsa_kernarg_size 80
  .amdhsa_user_sgpr_count 2
  .amdhsa_user_sgpr_kernarg_segment_ptr 1
  .amdhsa_system_sgpr_workgroup_id_x 1
.end_amdhsa_kernel
```
